```python
import torch

def _softmax(x, axis=-1):
    return torch.softmax(x, dim=axis)
def _gelu(x):
    return torch.nn.functional.gelu(x, approximate="tanh")
def _silu(x):
    return torch.nn.functional.silu(x)
def _sigmoid(x):
    return torch.sigmoid(x)
def _layernorm(x, axis=-1, eps=1e-5):
    m = x.mean(dim=axis, keepdim=True)
    v = x.var(dim=axis, keepdim=True, unbiased=False)
    return (x - m) / torch.sqrt(v + eps)
def _scatter_add(tgt, idx, src, axis=0):
    return tgt.clone().index_add_(axis, idx, src)
def _segment_sum(src, seg, n):
    out = torch.zeros((n,) + src.shape[1:], dtype=src.dtype)
    return out.index_add_(0, seg, src)
def _pad(x, pw):
    flat = tuple(v for pair in reversed(pw) for v in pair)
    return torch.nn.functional.pad(x, flat)

kernel_name = 'concat_heads__gqa_block_cached__gqa_block_cached__decode'

def setup_inputs():

    _w = (lambda a: (lambda t: t.to(torch.bfloat16) if t.is_floating_point() else t)(torch.as_tensor(a)))
    def _A_setup():
        B, Sq, D = 4, 1, 640
        Hq, Hkv, Sk, Dh = 32, 32, 4096, 128
        assert Hq % Hkv == 0, (Hq, Hkv)
        return {
            "x": _w((lambda *s: torch.randn(*s, dtype=torch.bfloat16) * 0.8)(B, Sq, D)),
            "k_cache": _w((lambda *s: torch.randn(*s, dtype=torch.bfloat16) * 0.8)(B, Hkv, Sk, Dh)),
            "v_cache": _w((lambda *s: torch.randn(*s, dtype=torch.bfloat16) * 0.05)(B, Hkv, Sk, Dh)),
            "wq": _w((lambda *s: torch.randn(*s, dtype=torch.bfloat16) * 0.8)(D, Hq * Dh) * (D ** -0.5)),
            "wo": _w((lambda *s: torch.randn(*s, dtype=torch.bfloat16) * 0.05)(Hq * Dh, D) * ((Hq * Dh) ** -0.5)),
        }
    _A_in = _A_setup()

    def _B_setup():
        B, Sq, D = 4, 1, 640
        Hq, Hkv, Sk, Dh = 32, 32, 4096, 128
        assert Hq % Hkv == 0, (Hq, Hkv)
        return {
            "x": _w((lambda *s: torch.randn(*s, dtype=torch.bfloat16) * 0.8)(B, Sq, D)),
            "k_cache": _w((lambda *s: torch.randn(*s, dtype=torch.bfloat16) * 0.8)(B, Hkv, Sk, Dh)),
            "v_cache": _w((lambda *s: torch.randn(*s, dtype=torch.bfloat16) * 0.05)(B, Hkv, Sk, Dh)),
            "wq": _w((lambda *s: torch.randn(*s, dtype=torch.bfloat16) * 0.8)(D, Hq * Dh) * (D ** -0.5)),
            "wo": _w((lambda *s: torch.randn(*s, dtype=torch.bfloat16) * 0.05)(Hq * Dh, D) * ((Hq * Dh) ** -0.5)),
        }
    _B_in = _B_setup()

    return {
        "A_x": _A_in["x"],
        "A_k_cache": _A_in["k_cache"],
        "A_v_cache": _A_in["v_cache"],
        "A_wq": _A_in["wq"],
        "A_wo": _A_in["wo"],
        "B_x": _B_in["x"],
        "B_k_cache": _B_in["k_cache"],
        "B_v_cache": _B_in["v_cache"],
        "B_wq": _B_in["wq"],
        "B_wo": _B_in["wo"],
    }

def reference(A_x, A_k_cache, A_v_cache, A_wq, A_wo, B_x, B_k_cache, B_v_cache, B_wq, B_wo):
    def _A_ref(x, k_cache, v_cache, wq, wo):
        B, Sq, D = x.shape
        Hq, Dh = 32, 128
        Hkv = k_cache.shape[1]
        rep = Hq // Hkv
        q = (lambda x, *d: x.permute(*d))((x @ wq).reshape(B, Sq, Hq, Dh), 0, 2, 1, 3)
        k = (lambda x, n, axis: torch.repeat_interleave(x, n, dim=axis))(k_cache, rep, axis=1)
        v = (lambda x, n, axis: torch.repeat_interleave(x, n, dim=axis))(v_cache, rep, axis=1)
        scores = torch.einsum("bhqd,bhkd->bhqk", q, k) * (Dh ** -0.5)
        p = _softmax(scores, axis=-1)
        o = torch.einsum("bhqk,bhkd->bhqd", p, v)
        return (lambda x, *d: x.permute(*d))(o, 0, 2, 1, 3).reshape(B, Sq, Hq * Dh) @ wo

    def _B_ref(x, k_cache, v_cache, wq, wo):
        B, Sq, D = x.shape
        Hq, Dh = 32, 128
        Hkv = k_cache.shape[1]
        rep = Hq // Hkv
        q = (lambda x, *d: x.permute(*d))((x @ wq).reshape(B, Sq, Hq, Dh), 0, 2, 1, 3)
        k = (lambda x, n, axis: torch.repeat_interleave(x, n, dim=axis))(k_cache, rep, axis=1)
        v = (lambda x, n, axis: torch.repeat_interleave(x, n, dim=axis))(v_cache, rep, axis=1)
        scores = torch.einsum("bhqd,bhkd->bhqk", q, k) * (Dh ** -0.5)
        p = _softmax(scores, axis=-1)
        o = torch.einsum("bhqk,bhkd->bhqd", p, v)
        return (lambda x, *d: x.permute(*d))(o, 0, 2, 1, 3).reshape(B, Sq, Hq * Dh) @ wo

    a = _A_ref(A_x, A_k_cache, A_v_cache, A_wq, A_wo)
    b = _B_ref(B_x, B_k_cache, B_v_cache, B_wq, B_wo)
    return torch.concatenate([a, b], axis=-1)
```

```asm
; @launch grid=(256,1,1) block=(256,1,1) lds=18432
.amdgcn_target "amdgcn-amd-amdhsa--gfx950"
.text
.globl concat_heads__gqa_block_cached__gqa_block_cached__decode_kernel
.p2align 8
.type concat_heads__gqa_block_cached__gqa_block_cached__decode_kernel,@function
concat_heads__gqa_block_cached__gqa_block_cached__decode_kernel:
    s_cmp_ge_u32 s2, 256
    s_cbranch_scc1 L_end
    s_lshr_b32 s3, s2, 7
    s_mul_i32 s7, s3, 40
    s_add_u32 s4, s0, s7
    s_addc_u32 s5, s1, 0
    s_load_dwordx8 s[8:15], s[4:5], 0
    s_load_dwordx2 s[22:23], s[4:5], 32
    s_load_dwordx4 s[16:19], s[0:1], 80
    s_load_dwordx2 s[20:21], s[0:1], 96
    v_lshrrev_b32 v1, 6, v0
    v_and_b32 v0, 63, v0
    v_readfirstlane_b32 s6, v1
    v_lshlrev_b32 v1, 4, v0
    v_lshrrev_b32 v208, 4, v0
    v_and_b32 v209, 15, v0
    v_bfe_u32 v210, v0, 2, 2
    v_and_b32 v211, 3, v0
    v_lshlrev_b32 v212, 4, v209
    v_mul_u32_u24 v2, 81920, v208
    v_add_u32 v2, v2, v212
    s_bfe_u32 s52, s2, 0x20005
    v_add_u32 v213, s52, v210
    v_and_b32 v213, 3, v213
    v_mul_u32_u24 v229, 80, v213
    v_mul_u32_u24 v213, 20, v208
    v_add_u32 v229, v229, v213
    s_mul_i32 s7, s6, 40
    v_add_u32 v213, s7, v0
    v_lshlrev_b32 v36, 4, v213
    v_lshlrev_b32 v37, 3, v213
    v_cmp_gt_u32 vcc, 40, v0
    v_bfrev_b32 v214, 1
    v_mov_b32 v216, -1
    v_cndmask_b32 v36, v214, v36, vcc
    v_cndmask_b32 v37, v214, v37, vcc
    v_mov_b32 v217, -1
    v_mov_b32 v218, -1
    v_mov_b32 v219, -1
    s_and_b32 s62, s2, 31
    s_and_b32 s7, s2, 127
    s_lshl_b32 s63, s7, 20
    s_lshr_b32 s54, s2, 5
    s_mul_i32 s57, s6, 1310720
    s_mul_i32 s61, s6, 320
    s_lshl_b32 s56, s6, 12
    s_mul_i32 s58, s62, 2560
    s_mov_b32 s26, 0x100000
    s_mov_b32 s27, 0x20000
    s_mov_b32 s30, 0x100000
    s_mov_b32 s31, 0x20000
    s_mov_b32 s35, 0x20000
    s_mov_b32 s38, 163840
    s_mov_b32 s39, 0x20000
    s_mov_b32 s42, 1280
    s_mov_b32 s43, 0x20000
    s_mov_b32 s46, 81920
    s_mov_b32 s47, 0x20000
    s_mov_b32 s50, 1280
    s_mov_b32 s51, 0x20000
    s_lshl_b32 s7, s62, 8
    s_sub_u32 s34, 5242880, s7
    s_mul_i32 s59, s52, 1280
    s_mul_i32 s60, s54, 81920
    s_waitcnt lgkmcnt(0)
    s_mov_b32 s40, s8
    s_mov_b32 s41, s9
    s_mov_b32 s42, 5120
    s_add_u32 s32, s14, s7
    s_addc_u32 s33, s15, 0
    s_mul_i32 s7, s52, 80
    s_add_u32 s61, s61, s7
    v_mul_u32_u24 v231, 1280, v210
    v_mul_u32_u24 v213, 20, v208
    v_add_u32 v231, v231, v213
    buffer_load_dwordx4 v[220:223], v231, s[40:43], s61 offen
    buffer_load_dword v224, v231, s[40:43], s61 offen offset:16
    s_add_u32 s24, s10, s63
    s_addc_u32 s25, s11, 0
    s_mov_b32 s55, s56
    s_add_u32 s7, s52, 0
    s_and_b32 s7, s7, 3
    s_mul_i32 s7, s7, 327680
    s_add_u32 s53, s57, s7
    buffer_load_dwordx4 a[0:3], v2, s[32:35], s53 offen nt
    s_add_u32 s53, s53, 8192
    buffer_load_dwordx4 a[4:7], v2, s[32:35], s53 offen nt
    s_add_u32 s53, s53, 8192
    buffer_load_dwordx4 a[8:11], v2, s[32:35], s53 offen nt
    s_add_u32 s53, s53, 8192
    buffer_load_dwordx4 a[12:15], v2, s[32:35], s53 offen nt
    s_add_u32 s53, s53, 8192
    s_add_u32 s44, s20, s60
    s_addc_u32 s45, s21, 0
    buffer_store_dwordx4 v[216:219], v36, s[44:47], s58 offen sc1
    buffer_load_dwordx4 a[16:19], v2, s[32:35], s53 offen nt
    s_add_u32 s53, s53, 8192
    buffer_load_dwordx4 a[20:23], v2, s[32:35], s53 offen nt
    s_add_u32 s53, s53, 8192
    buffer_load_dwordx4 a[24:27], v2, s[32:35], s53 offen nt
    s_add_u32 s53, s53, 8192
    buffer_load_dwordx4 a[28:31], v2, s[32:35], s53 offen nt
    s_add_u32 s53, s53, 8192
    s_lshl_b32 s7, s3, 5
    s_add_u32 s7, s7, s62
    s_lshl_b32 s7, s7, 13
    s_add_u32 s7, s7, 0x200000
    s_add_u32 s64, s20, s7
    s_addc_u32 s65, s21, 0
    s_mov_b32 s66, 8192
    s_mov_b32 s67, 0x20000
    s_add_u32 s70, s52, s6
    s_and_b32 s70, s70, 3
    s_lshl_b32 s68, s70, 11
    s_lshl_b32 s7, s52, 9
    s_add_u32 s68, s68, s7
    s_sub_u32 s71, s52, s6
    s_and_b32 s71, s71, 3
    s_lshl_b32 s69, s71, 9
    s_lshl_b32 s7, s52, 11
    s_add_u32 s69, s69, s7
    v_lshlrev_b32 v225, 3, v0
    buffer_store_dwordx2 v[216:217], v225, s[64:67], s69 offen
    s_add_u32 s28, s12, s63
    s_addc_u32 s29, s13, 0
    s_mul_i32 s7, s62, 163840
    s_add_u32 s36, s22, s7
    s_addc_u32 s37, s23, 0
    s_mul_i32 s7, s52, 2560
    s_mul_i32 s59, s3, 1280
    s_add_u32 s7, s7, s59
    s_add_u32 s48, s16, s7
    s_addc_u32 s49, s17, 0
    s_lshl_b32 s61, s54, 5
    s_mul_i32 s54, s6, 40960
    s_mov_b32 s59, 0x3db504f3
    v_and_b32 v213, 1, v211
    v_lshlrev_b32 v213, 4, v213
    v_lshlrev_b32 v213, v213, 1
    v_cmp_gt_u32 vcc, 2, v211
    v_mul_u32_u24 v228, 0xffff, v213
    v_mul_u32_u24 v3, 1280, v208
    v_cndmask_b32 v226, 0, v213, vcc
    v_cndmask_b32 v227, v213, 0, vcc
    v_add_u32 v3, v3, v212
    v_mul_u32_u24 v4, 0xffff, v226
    v_mul_u32_u24 v5, 0xffff, v227
    v_lshrrev_b32 v214, 1, v209
    v_cmp_eq_u32 vcc, 0, v214
    s_nop 1
    v_cndmask_b32 v32, 0, v228, vcc
    v_cmp_eq_u32 vcc, 1, v214
    s_nop 1
    v_cndmask_b32 v33, 0, v228, vcc
    v_cmp_eq_u32 vcc, 2, v214
    s_nop 1
    v_cndmask_b32 v34, 0, v228, vcc
    v_cmp_eq_u32 vcc, 3, v214
    s_nop 1
    v_cndmask_b32 v35, 0, v228, vcc
    s_lshl_b32 s7, s6, 9
    v_lshlrev_b32 v230, 5, v209
    v_lshlrev_b32 v213, 3, v208
    v_add3_u32 v38, v230, v213, s7
    v_and_b32 v213, 7, v209
    v_lshlrev_b32 v213, 2, v213
    s_lshl_b32 s7, s6, 5
    v_add3_u32 v213, v213, v208, s7
    v_lshlrev_b32 v39, 2, v213
    v_add_u32 v39, 4096, v39
    s_mul_i32 s7, s6, 2560
    s_add_u32 s7, s7, 8192
    v_lshlrev_b32 v213, 4, v208
    v_add3_u32 v40, v230, v213, s7
    v_min_u32 v213, 39, v0
    s_mul_i32 s7, s6, 640
    s_add_u32 s7, s7, 8192
    v_lshlrev_b32 v213, 4, v213
    v_add_u32 v41, s7, v213
    v_mov_b32 v10, 0xff800000
    v_mov_b32 v11, 0
    v_mov_b32 v31, 0
    s_add_u32 s8, s20, 0x100000
    s_addc_u32 s9, s21, 0
    s_mov_b32 s10, 4096
    s_mov_b32 s11, 0x20000
    s_and_b32 s7, s2, 7
    s_lshl_b32 s7, s7, 9
    v_lshlrev_b32 v169, 3, v0
    v_add_u32 v169, s7, v169
    s_lshr_b32 s5, s2, 3
    s_lshl_b32 s5, s5, 2
    s_add_u32 s5, s5, s6
    s_lshl_b32 s5, s5, 2
    s_add_u32 s7, s7, s5
    v_mov_b32 v168, s7
    v_bfrev_b32 v170, 1
    v_cmp_eq_u32 vcc, 0, v0
    s_nop 1
    v_cndmask_b32 v168, v170, v168, vcc
    s_lshr_b32 s5, s2, 3
    s_or_b32 s5, s5, s6
    s_cmp_lg_u32 s5, 0
    s_cbranch_scc1 L_noclrX
    s_and_b32 s7, s2, 7
    s_lshl_b32 s7, s7, 9
    v_bfrev_b32 v144, 1
    v_bfrev_b32 v145, 1
    v_bfrev_b32 v146, 1
    v_bfrev_b32 v147, 1
    s_mov_b64 exec, 0xffffffff
    buffer_store_dwordx4 v[144:147], v1, s[8:11], s7 offen sc1
    s_mov_b64 exec, -1
L_noclrX:
    s_waitcnt vmcnt(8)
    v_mul_u32_u24_sdwa v232, v220, v226 dst_sel:DWORD dst_unused:UNUSED_PAD src0_sel:WORD_0 src1_sel:DWORD
    v_mul_u32_u24_sdwa v233, v220, v227 dst_sel:DWORD dst_unused:UNUSED_PAD src0_sel:WORD_0 src1_sel:DWORD
    v_mul_u32_u24_sdwa v234, v220, v226 dst_sel:DWORD dst_unused:UNUSED_PAD src0_sel:WORD_1 src1_sel:DWORD
    v_mul_u32_u24_sdwa v235, v220, v227 dst_sel:DWORD dst_unused:UNUSED_PAD src0_sel:WORD_1 src1_sel:DWORD
    v_mul_u32_u24_sdwa v236, v221, v226 dst_sel:DWORD dst_unused:UNUSED_PAD src0_sel:WORD_0 src1_sel:DWORD
    v_mul_u32_u24_sdwa v237, v221, v227 dst_sel:DWORD dst_unused:UNUSED_PAD src0_sel:WORD_0 src1_sel:DWORD
    v_mul_u32_u24_sdwa v238, v221, v226 dst_sel:DWORD dst_unused:UNUSED_PAD src0_sel:WORD_1 src1_sel:DWORD
    v_mul_u32_u24_sdwa v239, v221, v227 dst_sel:DWORD dst_unused:UNUSED_PAD src0_sel:WORD_1 src1_sel:DWORD
    v_mul_u32_u24_sdwa v240, v222, v226 dst_sel:DWORD dst_unused:UNUSED_PAD src0_sel:WORD_0 src1_sel:DWORD
    v_mul_u32_u24_sdwa v241, v222, v227 dst_sel:DWORD dst_unused:UNUSED_PAD src0_sel:WORD_0 src1_sel:DWORD
    v_mul_u32_u24_sdwa v242, v222, v226 dst_sel:DWORD dst_unused:UNUSED_PAD src0_sel:WORD_1 src1_sel:DWORD
    v_mul_u32_u24_sdwa v243, v222, v227 dst_sel:DWORD dst_unused:UNUSED_PAD src0_sel:WORD_1 src1_sel:DWORD
    v_mul_u32_u24_sdwa v244, v223, v226 dst_sel:DWORD dst_unused:UNUSED_PAD src0_sel:WORD_0 src1_sel:DWORD
    v_mul_u32_u24_sdwa v245, v223, v227 dst_sel:DWORD dst_unused:UNUSED_PAD src0_sel:WORD_0 src1_sel:DWORD
    v_mul_u32_u24_sdwa v246, v223, v226 dst_sel:DWORD dst_unused:UNUSED_PAD src0_sel:WORD_1 src1_sel:DWORD
    v_mul_u32_u24_sdwa v247, v223, v227 dst_sel:DWORD dst_unused:UNUSED_PAD src0_sel:WORD_1 src1_sel:DWORD
    v_mul_u32_u24_sdwa v248, v224, v226 dst_sel:DWORD dst_unused:UNUSED_PAD src0_sel:WORD_0 src1_sel:DWORD
    v_mul_u32_u24_sdwa v249, v224, v227 dst_sel:DWORD dst_unused:UNUSED_PAD src0_sel:WORD_0 src1_sel:DWORD
    v_mul_u32_u24_sdwa v250, v224, v226 dst_sel:DWORD dst_unused:UNUSED_PAD src0_sel:WORD_1 src1_sel:DWORD
    v_mul_u32_u24_sdwa v251, v224, v227 dst_sel:DWORD dst_unused:UNUSED_PAD src0_sel:WORD_1 src1_sel:DWORD
    s_waitcnt vmcnt(7)
    buffer_load_dwordx4 a[32:35], v2, s[32:35], s53 offen nt
    s_add_u32 s53, s53, 8192
    v_mfma_f32_4x4x4_16b_bf16 v[44:47], v[232:233], a[0:1], 0 cbsz:2 abid:0
    v_mfma_f32_4x4x4_16b_bf16 v[48:51], v[232:233], a[2:3], 0 cbsz:2 abid:0
    v_mfma_f32_4x4x4_16b_bf16 v[52:55], v[232:233], a[0:1], 0 cbsz:2 abid:1
    v_mfma_f32_4x4x4_16b_bf16 v[56:59], v[232:233], a[2:3], 0 cbsz:2 abid:1
    v_mfma_f32_4x4x4_16b_bf16 v[60:63], v[232:233], a[0:1], 0 cbsz:2 abid:2
    v_mfma_f32_4x4x4_16b_bf16 v[64:67], v[232:233], a[2:3], 0 cbsz:2 abid:2
    v_mfma_f32_4x4x4_16b_bf16 v[68:71], v[232:233], a[0:1], 0 cbsz:2 abid:3
    v_mfma_f32_4x4x4_16b_bf16 v[72:75], v[232:233], a[2:3], 0 cbsz:2 abid:3
    s_waitcnt vmcnt(7)
    buffer_load_dwordx4 a[36:39], v2, s[32:35], s53 offen nt
    v_mfma_f32_4x4x4_16b_bf16 v[44:47], v[234:235], a[4:5], v[44:47] cbsz:2 abid:0
    v_mfma_f32_4x4x4_16b_bf16 v[48:51], v[234:235], a[6:7], v[48:51] cbsz:2 abid:0
    v_mfma_f32_4x4x4_16b_bf16 v[52:55], v[234:235], a[4:5], v[52:55] cbsz:2 abid:1
    v_mfma_f32_4x4x4_16b_bf16 v[56:59], v[234:235], a[6:7], v[56:59] cbsz:2 abid:1
    v_mfma_f32_4x4x4_16b_bf16 v[60:63], v[234:235], a[4:5], v[60:63] cbsz:2 abid:2
    v_mfma_f32_4x4x4_16b_bf16 v[64:67], v[234:235], a[6:7], v[64:67] cbsz:2 abid:2
    v_mfma_f32_4x4x4_16b_bf16 v[68:71], v[234:235], a[4:5], v[68:71] cbsz:2 abid:3
    v_mfma_f32_4x4x4_16b_bf16 v[72:75], v[234:235], a[6:7], v[72:75] cbsz:2 abid:3
    s_waitcnt vmcnt(7)
    buffer_load_dwordx4 v[80:83], v1, s[24:27], s56 offen offset:0 nt
    v_mfma_f32_4x4x4_16b_bf16 v[44:47], v[236:237], a[8:9], v[44:47] cbsz:2 abid:0
    v_mfma_f32_4x4x4_16b_bf16 v[48:51], v[236:237], a[10:11], v[48:51] cbsz:2 abid:0
    v_mfma_f32_4x4x4_16b_bf16 v[52:55], v[236:237], a[8:9], v[52:55] cbsz:2 abid:1
    v_mfma_f32_4x4x4_16b_bf16 v[56:59], v[236:237], a[10:11], v[56:59] cbsz:2 abid:1
    v_mfma_f32_4x4x4_16b_bf16 v[60:63], v[236:237], a[8:9], v[60:63] cbsz:2 abid:2
    v_mfma_f32_4x4x4_16b_bf16 v[64:67], v[236:237], a[10:11], v[64:67] cbsz:2 abid:2
    v_mfma_f32_4x4x4_16b_bf16 v[68:71], v[236:237], a[8:9], v[68:71] cbsz:2 abid:3
    v_mfma_f32_4x4x4_16b_bf16 v[72:75], v[236:237], a[10:11], v[72:75] cbsz:2 abid:3
    s_waitcnt vmcnt(7)
    buffer_load_dwordx4 v[84:87], v1, s[24:27], s56 offen offset:1024 nt
    v_mfma_f32_4x4x4_16b_bf16 v[44:47], v[238:239], a[12:13], v[44:47] cbsz:2 abid:0
    v_mfma_f32_4x4x4_16b_bf16 v[48:51], v[238:239], a[14:15], v[48:51] cbsz:2 abid:0
    v_mfma_f32_4x4x4_16b_bf16 v[52:55], v[238:239], a[12:13], v[52:55] cbsz:2 abid:1
    v_mfma_f32_4x4x4_16b_bf16 v[56:59], v[238:239], a[14:15], v[56:59] cbsz:2 abid:1
    v_mfma_f32_4x4x4_16b_bf16 v[60:63], v[238:239], a[12:13], v[60:63] cbsz:2 abid:2
    v_mfma_f32_4x4x4_16b_bf16 v[64:67], v[238:239], a[14:15], v[64:67] cbsz:2 abid:2
    v_mfma_f32_4x4x4_16b_bf16 v[68:71], v[238:239], a[12:13], v[68:71] cbsz:2 abid:3
    v_mfma_f32_4x4x4_16b_bf16 v[72:75], v[238:239], a[14:15], v[72:75] cbsz:2 abid:3
    s_waitcnt vmcnt(7)
    buffer_load_dwordx4 v[88:91], v1, s[24:27], s56 offen offset:2048 nt
    v_mfma_f32_4x4x4_16b_bf16 v[44:47], v[240:241], a[16:17], v[44:47] cbsz:2 abid:0
    v_mfma_f32_4x4x4_16b_bf16 v[48:51], v[240:241], a[18:19], v[48:51] cbsz:2 abid:0
    v_mfma_f32_4x4x4_16b_bf16 v[52:55], v[240:241], a[16:17], v[52:55] cbsz:2 abid:1
    v_mfma_f32_4x4x4_16b_bf16 v[56:59], v[240:241], a[18:19], v[56:59] cbsz:2 abid:1
    v_mfma_f32_4x4x4_16b_bf16 v[60:63], v[240:241], a[16:17], v[60:63] cbsz:2 abid:2
    v_mfma_f32_4x4x4_16b_bf16 v[64:67], v[240:241], a[18:19], v[64:67] cbsz:2 abid:2
    v_mfma_f32_4x4x4_16b_bf16 v[68:71], v[240:241], a[16:17], v[68:71] cbsz:2 abid:3
    v_mfma_f32_4x4x4_16b_bf16 v[72:75], v[240:241], a[18:19], v[72:75] cbsz:2 abid:3
    s_waitcnt vmcnt(7)
    buffer_load_dwordx4 v[92:95], v1, s[24:27], s56 offen offset:3072 nt
    s_add_u32 s56, s56, 32768
    v_mfma_f32_4x4x4_16b_bf16 v[44:47], v[242:243], a[20:21], v[44:47] cbsz:2 abid:0
    v_mfma_f32_4x4x4_16b_bf16 v[48:51], v[242:243], a[22:23], v[48:51] cbsz:2 abid:0
    v_mfma_f32_4x4x4_16b_bf16 v[52:55], v[242:243], a[20:21], v[52:55] cbsz:2 abid:1
    v_mfma_f32_4x4x4_16b_bf16 v[56:59], v[242:243], a[22:23], v[56:59] cbsz:2 abid:1
    v_mfma_f32_4x4x4_16b_bf16 v[60:63], v[242:243], a[20:21], v[60:63] cbsz:2 abid:2
    v_mfma_f32_4x4x4_16b_bf16 v[64:67], v[242:243], a[22:23], v[64:67] cbsz:2 abid:2
    v_mfma_f32_4x4x4_16b_bf16 v[68:71], v[242:243], a[20:21], v[68:71] cbsz:2 abid:3
    v_mfma_f32_4x4x4_16b_bf16 v[72:75], v[242:243], a[22:23], v[72:75] cbsz:2 abid:3
    s_waitcnt vmcnt(7)
    buffer_load_dwordx4 v[96:99], v1, s[24:27], s56 offen offset:0 nt
    v_mfma_f32_4x4x4_16b_bf16 v[44:47], v[244:245], a[24:25], v[44:47] cbsz:2 abid:0
    v_mfma_f32_4x4x4_16b_bf16 v[48:51], v[244:245], a[26:27], v[48:51] cbsz:2 abid:0
    v_mfma_f32_4x4x4_16b_bf16 v[52:55], v[244:245], a[24:25], v[52:55] cbsz:2 abid:1
    v_mfma_f32_4x4x4_16b_bf16 v[56:59], v[244:245], a[26:27], v[56:59] cbsz:2 abid:1
    v_mfma_f32_4x4x4_16b_bf16 v[60:63], v[244:245], a[24:25], v[60:63] cbsz:2 abid:2
    v_mfma_f32_4x4x4_16b_bf16 v[64:67], v[244:245], a[26:27], v[64:67] cbsz:2 abid:2
    v_mfma_f32_4x4x4_16b_bf16 v[68:71], v[244:245], a[24:25], v[68:71] cbsz:2 abid:3
    v_mfma_f32_4x4x4_16b_bf16 v[72:75], v[244:245], a[26:27], v[72:75] cbsz:2 abid:3
    s_waitcnt vmcnt(7)
    buffer_load_dwordx4 v[100:103], v1, s[24:27], s56 offen offset:1024 nt
    v_mfma_f32_4x4x4_16b_bf16 v[44:47], v[246:247], a[28:29], v[44:47] cbsz:2 abid:0
    v_mfma_f32_4x4x4_16b_bf16 v[48:51], v[246:247], a[30:31], v[48:51] cbsz:2 abid:0
    v_mfma_f32_4x4x4_16b_bf16 v[52:55], v[246:247], a[28:29], v[52:55] cbsz:2 abid:1
    v_mfma_f32_4x4x4_16b_bf16 v[56:59], v[246:247], a[30:31], v[56:59] cbsz:2 abid:1
    v_mfma_f32_4x4x4_16b_bf16 v[60:63], v[246:247], a[28:29], v[60:63] cbsz:2 abid:2
    v_mfma_f32_4x4x4_16b_bf16 v[64:67], v[246:247], a[30:31], v[64:67] cbsz:2 abid:2
    v_mfma_f32_4x4x4_16b_bf16 v[68:71], v[246:247], a[28:29], v[68:71] cbsz:2 abid:3
    v_mfma_f32_4x4x4_16b_bf16 v[72:75], v[246:247], a[30:31], v[72:75] cbsz:2 abid:3
    s_waitcnt vmcnt(7)
    buffer_load_dwordx4 v[104:107], v1, s[24:27], s56 offen offset:2048 nt
    v_mfma_f32_4x4x4_16b_bf16 v[44:47], v[248:249], a[32:33], v[44:47] cbsz:2 abid:0
    v_mfma_f32_4x4x4_16b_bf16 v[48:51], v[248:249], a[34:35], v[48:51] cbsz:2 abid:0
    v_mfma_f32_4x4x4_16b_bf16 v[52:55], v[248:249], a[32:33], v[52:55] cbsz:2 abid:1
    v_mfma_f32_4x4x4_16b_bf16 v[56:59], v[248:249], a[34:35], v[56:59] cbsz:2 abid:1
    v_mfma_f32_4x4x4_16b_bf16 v[60:63], v[248:249], a[32:33], v[60:63] cbsz:2 abid:2
    v_mfma_f32_4x4x4_16b_bf16 v[64:67], v[248:249], a[34:35], v[64:67] cbsz:2 abid:2
    v_mfma_f32_4x4x4_16b_bf16 v[68:71], v[248:249], a[32:33], v[68:71] cbsz:2 abid:3
    v_mfma_f32_4x4x4_16b_bf16 v[72:75], v[248:249], a[34:35], v[72:75] cbsz:2 abid:3
    s_waitcnt vmcnt(7)
    buffer_load_dwordx4 v[108:111], v1, s[24:27], s56 offen offset:3072 nt
    s_add_u32 s56, s56, 32768
    v_mfma_f32_4x4x4_16b_bf16 v[44:47], v[250:251], a[36:37], v[44:47] cbsz:2 abid:0
    v_mfma_f32_4x4x4_16b_bf16 v[48:51], v[250:251], a[38:39], v[48:51] cbsz:2 abid:0
    v_mfma_f32_4x4x4_16b_bf16 v[52:55], v[250:251], a[36:37], v[52:55] cbsz:2 abid:1
    v_mfma_f32_4x4x4_16b_bf16 v[56:59], v[250:251], a[38:39], v[56:59] cbsz:2 abid:1
    v_mfma_f32_4x4x4_16b_bf16 v[60:63], v[250:251], a[36:37], v[60:63] cbsz:2 abid:2
    v_mfma_f32_4x4x4_16b_bf16 v[64:67], v[250:251], a[38:39], v[64:67] cbsz:2 abid:2
    v_mfma_f32_4x4x4_16b_bf16 v[68:71], v[250:251], a[36:37], v[68:71] cbsz:2 abid:3
    v_mfma_f32_4x4x4_16b_bf16 v[72:75], v[250:251], a[38:39], v[72:75] cbsz:2 abid:3
    s_mul_i32 s7, s6, 1536
    v_add_u32 v174, s7, v38
    s_lshl_b32 s7, s70, 9
    v_add_u32 v175, s7, v225
    v_permlane32_swap_b32 v44, v48
    v_permlane32_swap_b32 v45, v49
    v_permlane32_swap_b32 v46, v50
    v_permlane32_swap_b32 v47, v51
    v_permlane32_swap_b32 v52, v56
    v_permlane32_swap_b32 v53, v57
    v_permlane32_swap_b32 v54, v58
    v_permlane32_swap_b32 v55, v59
    v_permlane32_swap_b32 v60, v64
    v_permlane32_swap_b32 v61, v65
    v_permlane32_swap_b32 v62, v66
    v_permlane32_swap_b32 v63, v67
    v_permlane32_swap_b32 v68, v72
    v_permlane32_swap_b32 v69, v73
    v_permlane32_swap_b32 v70, v74
    v_permlane32_swap_b32 v71, v75
    v_pk_add_f32 v[44:45], v[44:45], v[48:49]
    v_pk_add_f32 v[46:47], v[46:47], v[50:51]
    v_pk_add_f32 v[52:53], v[52:53], v[56:57]
    v_pk_add_f32 v[54:55], v[54:55], v[58:59]
    v_pk_add_f32 v[60:61], v[60:61], v[64:65]
    v_pk_add_f32 v[62:63], v[62:63], v[66:67]
    v_pk_add_f32 v[68:69], v[68:69], v[72:73]
    v_pk_add_f32 v[70:71], v[70:71], v[74:75]
    v_permlane16_swap_b32 v44, v46
    v_permlane16_swap_b32 v45, v47
    v_permlane16_swap_b32 v52, v54
    v_permlane16_swap_b32 v53, v55
    v_permlane16_swap_b32 v60, v62
    v_permlane16_swap_b32 v61, v63
    v_permlane16_swap_b32 v68, v70
    v_permlane16_swap_b32 v69, v71
    v_pk_add_f32 v[44:45], v[44:45], v[46:47]
    ds_write_b64 v174, v[44:45] offset:8192
    v_pk_add_f32 v[52:53], v[52:53], v[54:55]
    ds_write_b64 v174, v[52:53] offset:8704
    v_pk_add_f32 v[60:61], v[60:61], v[62:63]
    ds_write_b64 v174, v[60:61] offset:9216
    v_pk_add_f32 v[68:69], v[68:69], v[70:71]
    ds_write_b64 v174, v[68:69] offset:9728
    buffer_load_dwordx4 v[112:115], v1, s[24:27], s56 offen offset:0 nt
    buffer_load_dwordx4 v[116:119], v1, s[24:27], s56 offen offset:1024 nt
    s_waitcnt lgkmcnt(0)
    s_barrier
    ds_read_b64 v[44:45], v175 offset:8192
    ds_read_b64 v[46:47], v175 offset:10240
    ds_read_b64 v[48:49], v175 offset:12288
    ds_read_b64 v[50:51], v175 offset:14336
    s_lshl_b32 s7, s71, 9
    v_add_u32 v175, s7, v225
    s_lshl_b32 s7, s6, 2
    v_mov_b32 v174, s7
    v_mov_b32 v30, 0
    s_waitcnt lgkmcnt(0)
    v_pk_add_f32 v[44:45], v[44:45], v[46:47]
    v_pk_add_f32 v[48:49], v[48:49], v[50:51]
    v_pk_add_f32 v[76:77], v[44:45], v[48:49]
    s_cmp_lg_u32 s6, 0
    s_cbranch_scc1 L_xpoll
    v_mov_b32 v78, v76
    v_mov_b32 v79, v77
    buffer_load_dwordx4 v[120:123], v1, s[24:27], s56 offen offset:2048 nt
    buffer_load_dwordx4 v[124:127], v1, s[24:27], s56 offen offset:3072 nt
    s_add_u32 s56, s56, 32768
    buffer_load_dwordx4 v[128:131], v1, s[24:27], s56 offen offset:0 nt
    buffer_load_dwordx4 v[132:135], v1, s[24:27], s56 offen offset:1024 nt
    buffer_load_dwordx4 v[136:139], v1, s[24:27], s56 offen offset:2048 nt
    buffer_load_dwordx4 v[140:143], v1, s[24:27], s56 offen offset:3072 nt
    s_add_u32 s56, s56, 32768
    s_cmp_ge_u32 s56, 0x100000
    s_cselect_b32 s7, 1032192, 0
    s_sub_u32 s56, s56, s7
    s_branch L_xok
L_xpoll:
    v_min_u32 v76, -2, v76
    v_min_u32 v77, -2, v77
    buffer_store_dwordx2 v[76:77], v225, s[64:67], s68 offen
    buffer_load_dwordx2 v[78:79], v225, s[64:67], s69 offen
    buffer_load_dwordx4 v[120:123], v1, s[24:27], s56 offen offset:2048 nt
    buffer_load_dwordx4 v[124:127], v1, s[24:27], s56 offen offset:3072 nt
    s_add_u32 s56, s56, 32768
    s_waitcnt vmcnt(2)
    v_max_u32 v171, v78, v79
    v_cmp_eq_u32 vcc, -1, v171
    s_nop 0
    s_cmp_lg_u64 vcc, 0
    s_cbranch_scc1 L_xa1
    buffer_load_dwordx4 v[128:131], v1, s[24:27], s56 offen offset:0 nt
    buffer_load_dwordx4 v[132:135], v1, s[24:27], s56 offen offset:1024 nt
    buffer_load_dwordx4 v[136:139], v1, s[24:27], s56 offen offset:2048 nt
    buffer_load_dwordx4 v[140:143], v1, s[24:27], s56 offen offset:3072 nt
    s_add_u32 s56, s56, 32768
    s_cmp_ge_u32 s56, 0x100000
    s_cselect_b32 s7, 1032192, 0
    s_sub_u32 s56, s56, s7
    s_branch L_xok
L_xa1:
    buffer_load_dwordx2 v[78:79], v225, s[64:67], s69 offen sc1
    buffer_load_dwordx4 v[128:131], v1, s[24:27], s56 offen offset:0 nt
    buffer_load_dwordx4 v[132:135], v1, s[24:27], s56 offen offset:1024 nt
    buffer_load_dwordx4 v[136:139], v1, s[24:27], s56 offen offset:2048 nt
    buffer_load_dwordx4 v[140:143], v1, s[24:27], s56 offen offset:3072 nt
    s_add_u32 s56, s56, 32768
    s_cmp_ge_u32 s56, 0x100000
    s_cselect_b32 s7, 1032192, 0
    s_sub_u32 s56, s56, s7
    s_waitcnt vmcnt(4)
    v_max_u32 v171, v78, v79
    v_cmp_eq_u32 vcc, -1, v171
    s_nop 0
    s_cmp_lg_u64 vcc, 0
    s_cbranch_scc1 L_xa2
    s_branch L_xok
L_xa2:
    s_mov_b32 s72, 12
L_xa3:
    s_sub_u32 s72, s72, 1
    s_cmp_eq_u32 s72, 0
    s_cbranch_scc1 L_xfail
    buffer_load_dwordx2 v[78:79], v225, s[64:67], s69 offen sc1
    s_waitcnt vmcnt(0)
    v_max_u32 v171, v78, v79
    v_cmp_eq_u32 vcc, -1, v171
    s_nop 0
    s_cmp_lg_u64 vcc, 0
    s_cbranch_scc1 L_xa3
    s_branch L_xok
L_xfail:
    v_mov_b32 v30, 1
L_xok:
    ds_write_b64 v175, v[78:79] offset:0
    ds_write_b32 v174, v30 offset:2176
    buffer_load_dwordx4 v[176:179], v1, s[28:31], s55 offen offset:0 nt
    buffer_load_dwordx4 v[180:183], v1, s[28:31], s55 offen offset:1024 nt
    buffer_load_dwordx4 v[184:187], v1, s[28:31], s55 offen offset:2048 nt
    buffer_load_dwordx4 v[188:191], v1, s[28:31], s55 offen offset:3072 nt
    s_add_u32 s55, s55, 32768
    s_waitcnt lgkmcnt(0)
    s_barrier
    ds_read_b128 v[76:79], v31 offset:2176
    ds_read_b128 v[44:47], v230 offset:0
    ds_read_b128 v[48:51], v230 offset:16
    ds_read_b128 v[52:55], v230 offset:512
    ds_read_b128 v[56:59], v230 offset:528
    ds_read_b128 v[60:63], v230 offset:1024
    ds_read_b128 v[64:67], v230 offset:1040
    ds_read_b128 v[68:71], v230 offset:1536
    ds_read_b128 v[72:75], v230 offset:1552
    s_waitcnt lgkmcnt(8)
    v_or3_b32 v76, v77, v78, v79
    s_nop 0
    v_readfirstlane_b32 s7, v76
    s_nop 0
    s_cmp_lg_u32 s7, 0
    s_cbranch_scc1 L_xfb
L_xback:
    v_mov_b32 v12, 0
    v_mov_b32 v13, 0
    v_mov_b32 v14, 0
    v_mov_b32 v15, 0
    v_mov_b32 v16, 0
    v_mov_b32 v17, 0
    v_mov_b32 v18, 0
    v_mov_b32 v19, 0
    s_waitcnt lgkmcnt(4)
    v_pk_add_f32 v[44:45], v[44:45], v[52:53]
    v_pk_add_f32 v[46:47], v[46:47], v[54:55]
    v_pk_add_f32 v[48:49], v[48:49], v[56:57]
    v_pk_add_f32 v[50:51], v[50:51], v[58:59]
    s_waitcnt lgkmcnt(0)
    v_pk_add_f32 v[60:61], v[60:61], v[68:69]
    v_pk_add_f32 v[62:63], v[62:63], v[70:71]
    v_pk_add_f32 v[64:65], v[64:65], v[72:73]
    v_pk_add_f32 v[66:67], v[66:67], v[74:75]
    v_pk_add_f32 v[44:45], v[44:45], v[60:61]
    v_pk_add_f32 v[46:47], v[46:47], v[62:63]
    v_pk_add_f32 v[48:49], v[48:49], v[64:65]
    v_pk_add_f32 v[50:51], v[50:51], v[66:67]
    v_cvt_pk_bf16_f32 v6, v44, v45
    v_cvt_pk_bf16_f32 v7, v46, v47
    v_cvt_pk_bf16_f32 v8, v48, v49
    v_cvt_pk_bf16_f32 v9, v50, v51
    s_waitcnt vmcnt(19)
    v_dot2_f32_bf16 v20, v80, v6, 0
    v_dot2_f32_bf16 v20, v81, v7, v20
    v_dot2_f32_bf16 v20, v82, v8, v20
    v_dot2_f32_bf16 v20, v83, v9, v20
    s_waitcnt vmcnt(18)
    v_dot2_f32_bf16 v21, v84, v6, 0
    v_dot2_f32_bf16 v21, v85, v7, v21
    v_dot2_f32_bf16 v21, v86, v8, v21
    v_dot2_f32_bf16 v21, v87, v9, v21
    buffer_load_dwordx4 v[192:195], v1, s[28:31], s55 offen offset:0 nt
    s_waitcnt vmcnt(18)
    v_dot2_f32_bf16 v22, v88, v6, 0
    v_dot2_f32_bf16 v22, v89, v7, v22
    v_dot2_f32_bf16 v22, v90, v8, v22
    v_dot2_f32_bf16 v22, v91, v9, v22
    s_waitcnt vmcnt(17)
    v_dot2_f32_bf16 v23, v92, v6, 0
    v_dot2_f32_bf16 v23, v93, v7, v23
    v_dot2_f32_bf16 v23, v94, v8, v23
    v_dot2_f32_bf16 v23, v95, v9, v23
    v_add_f32_dpp v20, v20, v20 row_ror:8 row_mask:0xf bank_mask:0x3
    v_add_f32_dpp v21, v21, v21 row_ror:8 row_mask:0xf bank_mask:0x3
    s_nop 0
    v_add_f32_dpp v20, v22, v22 row_ror:8 row_mask:0xf bank_mask:0xc
    v_add_f32_dpp v21, v23, v23 row_ror:8 row_mask:0xf bank_mask:0xc
    s_nop 0
    v_add_f32_dpp v144, v20, v20 row_shl:4 row_mask:0xf bank_mask:0x5
    s_nop 1
    v_add_f32_dpp v144, v21, v21 row_shr:4 row_mask:0xf bank_mask:0xa
    s_nop 1
    v_add_f32_dpp v144, v144, v144 quad_perm:[1,0,3,2] row_mask:0xf bank_mask:0xf
    s_nop 1
    v_add_f32_dpp v144, v144, v144 quad_perm:[2,3,0,1] row_mask:0xf bank_mask:0xf
    v_cvt_pk_bf16_f32 v144, v144, v144
    v_lshlrev_b32 v144, 16, v144
    v_mul_f32 v144, s59, v144
    v_cvt_pk_bf16_f32 v144, v144, v144
    v_lshlrev_b32 v144, 16, v144
    buffer_load_dwordx4 v[196:199], v1, s[28:31], s55 offen offset:1024 nt
    s_waitcnt vmcnt(17)
    v_dot2_f32_bf16 v20, v96, v6, 0
    v_dot2_f32_bf16 v20, v97, v7, v20
    v_dot2_f32_bf16 v20, v98, v8, v20
    v_dot2_f32_bf16 v20, v99, v9, v20
    s_waitcnt vmcnt(16)
    v_dot2_f32_bf16 v21, v100, v6, 0
    v_dot2_f32_bf16 v21, v101, v7, v21
    v_dot2_f32_bf16 v21, v102, v8, v21
    v_dot2_f32_bf16 v21, v103, v9, v21
    buffer_load_dwordx4 v[200:203], v1, s[28:31], s55 offen offset:2048 nt
    buffer_load_dwordx4 a[0:3], v3, s[36:39], s54 offen offset:0 nt
    s_waitcnt vmcnt(17)
    v_dot2_f32_bf16 v22, v104, v6, 0
    v_dot2_f32_bf16 v22, v105, v7, v22
    v_dot2_f32_bf16 v22, v106, v8, v22
    v_dot2_f32_bf16 v22, v107, v9, v22
    s_waitcnt vmcnt(16)
    v_dot2_f32_bf16 v23, v108, v6, 0
    v_dot2_f32_bf16 v23, v109, v7, v23
    v_dot2_f32_bf16 v23, v110, v8, v23
    v_dot2_f32_bf16 v23, v111, v9, v23
    v_add_f32_dpp v20, v20, v20 row_ror:8 row_mask:0xf bank_mask:0x3
    v_add_f32_dpp v21, v21, v21 row_ror:8 row_mask:0xf bank_mask:0x3
    s_nop 0
    v_add_f32_dpp v20, v22, v22 row_ror:8 row_mask:0xf bank_mask:0xc
    v_add_f32_dpp v21, v23, v23 row_ror:8 row_mask:0xf bank_mask:0xc
    s_nop 0
    v_add_f32_dpp v145, v20, v20 row_shl:4 row_mask:0xf bank_mask:0x5
    s_nop 1
    v_add_f32_dpp v145, v21, v21 row_shr:4 row_mask:0xf bank_mask:0xa
    s_nop 1
    v_add_f32_dpp v145, v145, v145 quad_perm:[1,0,3,2] row_mask:0xf bank_mask:0xf
    s_nop 1
    v_add_f32_dpp v145, v145, v145 quad_perm:[2,3,0,1] row_mask:0xf bank_mask:0xf
    v_cvt_pk_bf16_f32 v145, v145, v145
    v_lshlrev_b32 v145, 16, v145
    v_mul_f32 v145, s59, v145
    v_cvt_pk_bf16_f32 v145, v145, v145
    v_lshlrev_b32 v145, 16, v145
    buffer_load_dwordx4 v[204:207], v1, s[28:31], s55 offen offset:3072 nt
    s_add_u32 s55, s55, 32768
    buffer_load_dwordx4 a[4:7], v3, s[36:39], s54 offen offset:256 nt
    s_waitcnt vmcnt(17)
    v_dot2_f32_bf16 v20, v112, v6, 0
    v_dot2_f32_bf16 v20, v113, v7, v20
    v_dot2_f32_bf16 v20, v114, v8, v20
    v_dot2_f32_bf16 v20, v115, v9, v20
    s_waitcnt vmcnt(16)
    v_dot2_f32_bf16 v21, v116, v6, 0
    v_dot2_f32_bf16 v21, v117, v7, v21
    v_dot2_f32_bf16 v21, v118, v8, v21
    v_dot2_f32_bf16 v21, v119, v9, v21
    buffer_load_dwordx4 v[112:115], v1, s[28:31], s55 offen offset:0 nt
    buffer_load_dwordx4 a[8:11], v3, s[36:39], s54 offen offset:512 nt
    s_waitcnt vmcnt(17)
    v_dot2_f32_bf16 v22, v120, v6, 0
    v_dot2_f32_bf16 v22, v121, v7, v22
    v_dot2_f32_bf16 v22, v122, v8, v22
    v_dot2_f32_bf16 v22, v123, v9, v22
    s_waitcnt vmcnt(16)
    v_dot2_f32_bf16 v23, v124, v6, 0
    v_dot2_f32_bf16 v23, v125, v7, v23
    v_dot2_f32_bf16 v23, v126, v8, v23
    v_dot2_f32_bf16 v23, v127, v9, v23
    v_add_f32_dpp v20, v20, v20 row_ror:8 row_mask:0xf bank_mask:0x3
    v_add_f32_dpp v21, v21, v21 row_ror:8 row_mask:0xf bank_mask:0x3
    s_nop 0
    v_add_f32_dpp v20, v22, v22 row_ror:8 row_mask:0xf bank_mask:0xc
    v_add_f32_dpp v21, v23, v23 row_ror:8 row_mask:0xf bank_mask:0xc
    s_nop 0
    v_add_f32_dpp v146, v20, v20 row_shl:4 row_mask:0xf bank_mask:0x5
    s_nop 1
    v_add_f32_dpp v146, v21, v21 row_shr:4 row_mask:0xf bank_mask:0xa
    s_nop 1
    v_add_f32_dpp v146, v146, v146 quad_perm:[1,0,3,2] row_mask:0xf bank_mask:0xf
    s_nop 1
    v_add_f32_dpp v146, v146, v146 quad_perm:[2,3,0,1] row_mask:0xf bank_mask:0xf
    v_cvt_pk_bf16_f32 v146, v146, v146
    v_lshlrev_b32 v146, 16, v146
    v_mul_f32 v146, s59, v146
    v_cvt_pk_bf16_f32 v146, v146, v146
    v_lshlrev_b32 v146, 16, v146
    buffer_load_dwordx4 v[116:119], v1, s[28:31], s55 offen offset:1024 nt
    buffer_load_dwordx4 a[12:15], v3, s[36:39], s54 offen offset:768 nt
    s_waitcnt vmcnt(17)
    v_dot2_f32_bf16 v20, v128, v6, 0
    v_dot2_f32_bf16 v20, v129, v7, v20
    v_dot2_f32_bf16 v20, v130, v8, v20
    v_dot2_f32_bf16 v20, v131, v9, v20
    s_waitcnt vmcnt(16)
    v_dot2_f32_bf16 v21, v132, v6, 0
    v_dot2_f32_bf16 v21, v133, v7, v21
    v_dot2_f32_bf16 v21, v134, v8, v21
    v_dot2_f32_bf16 v21, v135, v9, v21
    buffer_load_dwordx4 v[120:123], v1, s[28:31], s55 offen offset:2048 nt
    buffer_load_dwordx4 a[16:19], v3, s[36:39], s54 offen offset:1024 nt
    s_add_u32 s54, s54, 5120
    s_waitcnt vmcnt(17)
    v_dot2_f32_bf16 v22, v136, v6, 0
    v_dot2_f32_bf16 v22, v137, v7, v22
    v_dot2_f32_bf16 v22, v138, v8, v22
    v_dot2_f32_bf16 v22, v139, v9, v22
    s_waitcnt vmcnt(16)
    v_dot2_f32_bf16 v23, v140, v6, 0
    v_dot2_f32_bf16 v23, v141, v7, v23
    v_dot2_f32_bf16 v23, v142, v8, v23
    v_dot2_f32_bf16 v23, v143, v9, v23
    v_add_f32_dpp v20, v20, v20 row_ror:8 row_mask:0xf bank_mask:0x3
    v_add_f32_dpp v21, v21, v21 row_ror:8 row_mask:0xf bank_mask:0x3
    s_nop 0
    v_add_f32_dpp v20, v22, v22 row_ror:8 row_mask:0xf bank_mask:0xc
    v_add_f32_dpp v21, v23, v23 row_ror:8 row_mask:0xf bank_mask:0xc
    s_nop 0
    v_add_f32_dpp v147, v20, v20 row_shl:4 row_mask:0xf bank_mask:0x5
    s_nop 1
    v_add_f32_dpp v147, v21, v21 row_shr:4 row_mask:0xf bank_mask:0xa
    s_nop 1
    v_add_f32_dpp v147, v147, v147 quad_perm:[1,0,3,2] row_mask:0xf bank_mask:0xf
    s_nop 1
    v_add_f32_dpp v147, v147, v147 quad_perm:[2,3,0,1] row_mask:0xf bank_mask:0xf
    v_cvt_pk_bf16_f32 v147, v147, v147
    v_lshlrev_b32 v147, 16, v147
    v_mul_f32 v147, s59, v147
    v_cvt_pk_bf16_f32 v147, v147, v147
    v_lshlrev_b32 v147, 16, v147
    v_max3_f32 v24, v144, v145, v146
    v_max_f32 v24, v24, v147
    s_nop 1
    v_max_f32_dpp v24, v24, v24 row_ror:4 row_mask:0xf bank_mask:0xf
    s_nop 1
    v_max_f32_dpp v24, v24, v24 row_ror:8 row_mask:0xf bank_mask:0xf
    v_max_f32 v24, v24, v10
    v_sub_f32 v26, v10, v24
    v_sub_f32 v144, v144, v24
    v_sub_f32 v145, v145, v24
    v_sub_f32 v146, v146, v24
    v_sub_f32 v147, v147, v24
    v_mul_f32 v26, 0x3fb8aa3b, v26
    v_mul_f32 v144, 0x3fb8aa3b, v144
    v_mul_f32 v145, 0x3fb8aa3b, v145
    v_mul_f32 v146, 0x3fb8aa3b, v146
    v_mul_f32 v147, 0x3fb8aa3b, v147
    v_exp_f32 v26, v26
    v_exp_f32 v144, v144
    v_exp_f32 v145, v145
    v_exp_f32 v146, v146
    v_exp_f32 v147, v147
    v_mov_b32 v10, v24
    v_pk_mul_f32 v[12:13], v[12:13], v[26:27] op_sel_hi:[1,0]
    v_pk_mul_f32 v[14:15], v[14:15], v[26:27] op_sel_hi:[1,0]
    v_pk_mul_f32 v[16:17], v[16:17], v[26:27] op_sel_hi:[1,0]
    v_pk_mul_f32 v[18:19], v[18:19], v[26:27] op_sel_hi:[1,0]
    v_fma_f32 v11, v11, v26, v144
    v_cvt_pk_bf16_f32 v25, v144, v144
    v_and_b32 v152, v25, v4
    v_and_b32 v153, v25, v5
    v_cvt_pk_bf16_f32 v25, v145, v145
    v_add_f32 v11, v11, v145
    v_and_b32 v154, v25, v4
    v_and_b32 v155, v25, v5
    v_cvt_pk_bf16_f32 v25, v146, v146
    v_add_f32 v11, v11, v146
    v_and_b32 v156, v25, v4
    v_and_b32 v157, v25, v5
    v_cvt_pk_bf16_f32 v25, v147, v147
    v_add_f32 v11, v11, v147
    v_and_b32 v158, v25, v4
    v_and_b32 v159, v25, v5
    buffer_load_dwordx4 v[124:127], v1, s[28:31], s55 offen offset:3072 nt
    s_add_u32 s55, s55, 32768
    buffer_load_dwordx4 a[20:23], v3, s[36:39], s54 offen offset:0 nt
    s_waitcnt vmcnt(17)
    v_mfma_f32_4x4x4_16b_bf16 v[12:15], v[152:153], v[176:177], v[12:15] cbsz:2 abid:0
    v_mfma_f32_4x4x4_16b_bf16 v[16:19], v[152:153], v[178:179], v[16:19] cbsz:2 abid:0
    s_waitcnt vmcnt(16)
    v_mfma_f32_4x4x4_16b_bf16 v[12:15], v[152:153], v[180:181], v[12:15] cbsz:2 abid:1
    v_mfma_f32_4x4x4_16b_bf16 v[16:19], v[152:153], v[182:183], v[16:19] cbsz:2 abid:1
    buffer_load_dwordx4 v[128:131], v1, s[28:31], s55 offen offset:0 nt
    buffer_load_dwordx4 a[24:27], v3, s[36:39], s54 offen offset:256 nt
    s_waitcnt vmcnt(17)
    v_mfma_f32_4x4x4_16b_bf16 v[12:15], v[152:153], v[184:185], v[12:15] cbsz:2 abid:2
    v_mfma_f32_4x4x4_16b_bf16 v[16:19], v[152:153], v[186:187], v[16:19] cbsz:2 abid:2
    s_waitcnt vmcnt(16)
    v_mfma_f32_4x4x4_16b_bf16 v[12:15], v[152:153], v[188:189], v[12:15] cbsz:2 abid:3
    v_mfma_f32_4x4x4_16b_bf16 v[16:19], v[152:153], v[190:191], v[16:19] cbsz:2 abid:3
    buffer_load_dwordx4 v[132:135], v1, s[28:31], s55 offen offset:1024 nt
    buffer_load_dwordx4 a[28:31], v3, s[36:39], s54 offen offset:512 nt
    s_waitcnt vmcnt(17)
    v_mfma_f32_4x4x4_16b_bf16 v[12:15], v[154:155], v[192:193], v[12:15] cbsz:2 abid:0
    v_mfma_f32_4x4x4_16b_bf16 v[16:19], v[154:155], v[194:195], v[16:19] cbsz:2 abid:0
    s_waitcnt vmcnt(16)
    v_mfma_f32_4x4x4_16b_bf16 v[12:15], v[154:155], v[196:197], v[12:15] cbsz:2 abid:1
    v_mfma_f32_4x4x4_16b_bf16 v[16:19], v[154:155], v[198:199], v[16:19] cbsz:2 abid:1
    buffer_load_dwordx4 v[136:139], v1, s[28:31], s55 offen offset:2048 nt
    buffer_load_dwordx4 a[32:35], v3, s[36:39], s54 offen offset:768 nt
    s_waitcnt vmcnt(17)
    v_mfma_f32_4x4x4_16b_bf16 v[12:15], v[154:155], v[200:201], v[12:15] cbsz:2 abid:2
    v_mfma_f32_4x4x4_16b_bf16 v[16:19], v[154:155], v[202:203], v[16:19] cbsz:2 abid:2
    s_waitcnt vmcnt(15)
    v_mfma_f32_4x4x4_16b_bf16 v[12:15], v[154:155], v[204:205], v[12:15] cbsz:2 abid:3
    v_mfma_f32_4x4x4_16b_bf16 v[16:19], v[154:155], v[206:207], v[16:19] cbsz:2 abid:3
    buffer_load_dwordx4 v[140:143], v1, s[28:31], s55 offen offset:3072 nt
    s_add_u32 s55, s55, 32768
    s_cmp_ge_u32 s55, 0x100000
    s_cselect_b32 s7, 1032192, 0
    s_sub_u32 s55, s55, s7
    buffer_load_dwordx4 a[36:39], v3, s[36:39], s54 offen offset:1024 nt
    s_add_u32 s54, s54, 5120
    s_waitcnt vmcnt(11)
    buffer_load_dwordx4 v[80:83], v1, s[24:27], s56 offen offset:0 nt
    buffer_load_dwordx4 a[40:43], v3, s[36:39], s54 offen offset:0 nt
    v_mfma_f32_4x4x4_16b_bf16 v[12:15], v[156:157], v[112:113], v[12:15] cbsz:2 abid:0
    v_mfma_f32_4x4x4_16b_bf16 v[16:19], v[156:157], v[114:115], v[16:19] cbsz:2 abid:0
    s_waitcnt vmcnt(11)
    buffer_load_dwordx4 v[84:87], v1, s[24:27], s56 offen offset:1024 nt
    buffer_load_dwordx4 a[44:47], v3, s[36:39], s54 offen offset:256 nt
    v_mfma_f32_4x4x4_16b_bf16 v[12:15], v[156:157], v[116:117], v[12:15] cbsz:2 abid:1
    v_mfma_f32_4x4x4_16b_bf16 v[16:19], v[156:157], v[118:119], v[16:19] cbsz:2 abid:1
    s_waitcnt vmcnt(11)
    buffer_load_dwordx4 v[88:91], v1, s[24:27], s56 offen offset:2048 nt
    v_mfma_f32_4x4x4_16b_bf16 v[12:15], v[156:157], v[120:121], v[12:15] cbsz:2 abid:2
    v_mfma_f32_4x4x4_16b_bf16 v[16:19], v[156:157], v[122:123], v[16:19] cbsz:2 abid:2
    s_waitcnt vmcnt(10)
    buffer_load_dwordx4 v[92:95], v1, s[24:27], s56 offen offset:3072 nt
    s_add_u32 s56, s56, 32768
    buffer_load_dwordx4 a[48:51], v3, s[36:39], s54 offen offset:512 nt
    v_mfma_f32_4x4x4_16b_bf16 v[12:15], v[156:157], v[124:125], v[12:15] cbsz:2 abid:3
    v_mfma_f32_4x4x4_16b_bf16 v[16:19], v[156:157], v[126:127], v[16:19] cbsz:2 abid:3
    s_waitcnt vmcnt(10)
    buffer_load_dwordx4 v[96:99], v1, s[24:27], s56 offen offset:0 nt
    buffer_load_dwordx4 a[52:55], v3, s[36:39], s54 offen offset:768 nt
    v_mfma_f32_4x4x4_16b_bf16 v[12:15], v[158:159], v[128:129], v[12:15] cbsz:2 abid:0
    v_mfma_f32_4x4x4_16b_bf16 v[16:19], v[158:159], v[130:131], v[16:19] cbsz:2 abid:0
    s_waitcnt vmcnt(10)
    buffer_load_dwordx4 v[100:103], v1, s[24:27], s56 offen offset:1024 nt
    v_mfma_f32_4x4x4_16b_bf16 v[12:15], v[158:159], v[132:133], v[12:15] cbsz:2 abid:1
    v_mfma_f32_4x4x4_16b_bf16 v[16:19], v[158:159], v[134:135], v[16:19] cbsz:2 abid:1
    s_waitcnt vmcnt(9)
    buffer_load_dwordx4 v[104:107], v1, s[24:27], s56 offen offset:2048 nt
    buffer_load_dwordx4 a[56:59], v3, s[36:39], s54 offen offset:1024 nt
    s_add_u32 s54, s54, 5120
    v_mfma_f32_4x4x4_16b_bf16 v[12:15], v[158:159], v[136:137], v[12:15] cbsz:2 abid:2
    v_mfma_f32_4x4x4_16b_bf16 v[16:19], v[158:159], v[138:139], v[16:19] cbsz:2 abid:2
    s_waitcnt vmcnt(9)
    buffer_load_dwordx4 v[108:111], v1, s[24:27], s56 offen offset:3072 nt
    s_add_u32 s56, s56, 32768
    v_mfma_f32_4x4x4_16b_bf16 v[12:15], v[158:159], v[140:141], v[12:15] cbsz:2 abid:3
    v_mfma_f32_4x4x4_16b_bf16 v[16:19], v[158:159], v[142:143], v[16:19] cbsz:2 abid:3
    s_waitcnt vmcnt(8)
    buffer_load_dwordx4 v[112:115], v1, s[24:27], s56 offen offset:0 nt
    buffer_load_dwordx4 a[60:63], v3, s[36:39], s54 offen offset:0 nt
    v_dot2_f32_bf16 v20, v80, v6, 0
    v_dot2_f32_bf16 v20, v81, v7, v20
    v_dot2_f32_bf16 v20, v82, v8, v20
    v_dot2_f32_bf16 v20, v83, v9, v20
    s_waitcnt vmcnt(9)
    buffer_load_dwordx4 v[116:119], v1, s[24:27], s56 offen offset:1024 nt
    buffer_load_dwordx4 a[64:67], v3, s[36:39], s54 offen offset:256 nt
    v_dot2_f32_bf16 v21, v84, v6, 0
    v_dot2_f32_bf16 v21, v85, v7, v21
    v_dot2_f32_bf16 v21, v86, v8, v21
    v_dot2_f32_bf16 v21, v87, v9, v21
    s_waitcnt vmcnt(9)
    buffer_load_dwordx4 v[120:123], v1, s[24:27], s56 offen offset:2048 nt
    v_dot2_f32_bf16 v22, v88, v6, 0
    v_dot2_f32_bf16 v22, v89, v7, v22
    v_dot2_f32_bf16 v22, v90, v8, v22
    v_dot2_f32_bf16 v22, v91, v9, v22
    s_waitcnt vmcnt(8)
    buffer_load_dwordx4 v[124:127], v1, s[24:27], s56 offen offset:3072 nt
    s_add_u32 s56, s56, 32768
    buffer_load_dwordx4 a[68:71], v3, s[36:39], s54 offen offset:512 nt
    v_dot2_f32_bf16 v23, v92, v6, 0
    v_dot2_f32_bf16 v23, v93, v7, v23
    v_dot2_f32_bf16 v23, v94, v8, v23
    v_dot2_f32_bf16 v23, v95, v9, v23
    v_add_f32_dpp v20, v20, v20 row_ror:8 row_mask:0xf bank_mask:0x3
    v_add_f32_dpp v21, v21, v21 row_ror:8 row_mask:0xf bank_mask:0x3
    s_nop 0
    v_add_f32_dpp v20, v22, v22 row_ror:8 row_mask:0xf bank_mask:0xc
    v_add_f32_dpp v21, v23, v23 row_ror:8 row_mask:0xf bank_mask:0xc
    s_nop 0
    v_add_f32_dpp v144, v20, v20 row_shl:4 row_mask:0xf bank_mask:0x5
    s_nop 1
    v_add_f32_dpp v144, v21, v21 row_shr:4 row_mask:0xf bank_mask:0xa
    s_nop 1
    v_add_f32_dpp v144, v144, v144 quad_perm:[1,0,3,2] row_mask:0xf bank_mask:0xf
    s_nop 1
    v_add_f32_dpp v144, v144, v144 quad_perm:[2,3,0,1] row_mask:0xf bank_mask:0xf
    v_cvt_pk_bf16_f32 v144, v144, v144
    v_lshlrev_b32 v144, 16, v144
    v_mul_f32 v144, s59, v144
    v_cvt_pk_bf16_f32 v144, v144, v144
    v_lshlrev_b32 v144, 16, v144
    s_waitcnt vmcnt(9)
    buffer_load_dwordx4 v[128:131], v1, s[24:27], s56 offen offset:0 nt
    buffer_load_dwordx4 a[72:75], v3, s[36:39], s54 offen offset:768 nt
    v_dot2_f32_bf16 v20, v96, v6, 0
    v_dot2_f32_bf16 v20, v97, v7, v20
    v_dot2_f32_bf16 v20, v98, v8, v20
    v_dot2_f32_bf16 v20, v99, v9, v20
    s_waitcnt vmcnt(9)
    buffer_load_dwordx4 v[132:135], v1, s[24:27], s56 offen offset:1024 nt
    v_dot2_f32_bf16 v21, v100, v6, 0
    v_dot2_f32_bf16 v21, v101, v7, v21
    v_dot2_f32_bf16 v21, v102, v8, v21
    v_dot2_f32_bf16 v21, v103, v9, v21
    s_waitcnt vmcnt(9)
    buffer_load_dwordx4 v[136:139], v1, s[24:27], s56 offen offset:2048 nt
    buffer_load_dwordx4 a[76:79], v3, s[36:39], s54 offen offset:1024 nt
    s_add_u32 s54, s54, 5120
    v_dot2_f32_bf16 v22, v104, v6, 0
    v_dot2_f32_bf16 v22, v105, v7, v22
    v_dot2_f32_bf16 v22, v106, v8, v22
    v_dot2_f32_bf16 v22, v107, v9, v22
    s_waitcnt vmcnt(9)
    buffer_load_dwordx4 v[140:143], v1, s[24:27], s56 offen offset:3072 nt
    s_add_u32 s56, s56, 32768
    s_cmp_ge_u32 s56, 0x100000
    s_cselect_b32 s7, 1032192, 0
    s_sub_u32 s56, s56, s7
    v_dot2_f32_bf16 v23, v108, v6, 0
    v_dot2_f32_bf16 v23, v109, v7, v23
    v_dot2_f32_bf16 v23, v110, v8, v23
    v_dot2_f32_bf16 v23, v111, v9, v23
    v_add_f32_dpp v20, v20, v20 row_ror:8 row_mask:0xf bank_mask:0x3
    v_add_f32_dpp v21, v21, v21 row_ror:8 row_mask:0xf bank_mask:0x3
    s_nop 0
    v_add_f32_dpp v20, v22, v22 row_ror:8 row_mask:0xf bank_mask:0xc
    v_add_f32_dpp v21, v23, v23 row_ror:8 row_mask:0xf bank_mask:0xc
    s_nop 0
    v_add_f32_dpp v145, v20, v20 row_shl:4 row_mask:0xf bank_mask:0x5
    s_nop 1
    v_add_f32_dpp v145, v21, v21 row_shr:4 row_mask:0xf bank_mask:0xa
    s_nop 1
    v_add_f32_dpp v145, v145, v145 quad_perm:[1,0,3,2] row_mask:0xf bank_mask:0xf
    s_nop 1
    v_add_f32_dpp v145, v145, v145 quad_perm:[2,3,0,1] row_mask:0xf bank_mask:0xf
    v_cvt_pk_bf16_f32 v145, v145, v145
    v_lshlrev_b32 v145, 16, v145
    v_mul_f32 v145, s59, v145
    v_cvt_pk_bf16_f32 v145, v145, v145
    v_lshlrev_b32 v145, 16, v145
    s_waitcnt vmcnt(8)
    buffer_load_dwordx4 v[80:83], v1, s[28:31], s55 offen offset:0 nt
    buffer_load_dwordx4 a[80:83], v3, s[36:39], s54 offen offset:0 nt
    v_dot2_f32_bf16 v20, v112, v6, 0
    v_dot2_f32_bf16 v20, v113, v7, v20
    v_dot2_f32_bf16 v20, v114, v8, v20
    v_dot2_f32_bf16 v20, v115, v9, v20
    s_waitcnt vmcnt(9)
    buffer_load_dwordx4 v[84:87], v1, s[28:31], s55 offen offset:1024 nt
    buffer_load_dwordx4 a[84:87], v3, s[36:39], s54 offen offset:256 nt
    v_dot2_f32_bf16 v21, v116, v6, 0
    v_dot2_f32_bf16 v21, v117, v7, v21
    v_dot2_f32_bf16 v21, v118, v8, v21
    v_dot2_f32_bf16 v21, v119, v9, v21
    s_waitcnt vmcnt(9)
    buffer_load_dwordx4 v[88:91], v1, s[28:31], s55 offen offset:2048 nt
    v_dot2_f32_bf16 v22, v120, v6, 0
    v_dot2_f32_bf16 v22, v121, v7, v22
    v_dot2_f32_bf16 v22, v122, v8, v22
    v_dot2_f32_bf16 v22, v123, v9, v22
    s_waitcnt vmcnt(8)
    buffer_load_dwordx4 v[92:95], v1, s[28:31], s55 offen offset:3072 nt
    s_add_u32 s55, s55, 32768
    buffer_load_dwordx4 a[88:91], v3, s[36:39], s54 offen offset:512 nt
    v_dot2_f32_bf16 v23, v124, v6, 0
    v_dot2_f32_bf16 v23, v125, v7, v23
    v_dot2_f32_bf16 v23, v126, v8, v23
    v_dot2_f32_bf16 v23, v127, v9, v23
    v_add_f32_dpp v20, v20, v20 row_ror:8 row_mask:0xf bank_mask:0x3
    v_add_f32_dpp v21, v21, v21 row_ror:8 row_mask:0xf bank_mask:0x3
    s_nop 0
    v_add_f32_dpp v20, v22, v22 row_ror:8 row_mask:0xf bank_mask:0xc
    v_add_f32_dpp v21, v23, v23 row_ror:8 row_mask:0xf bank_mask:0xc
    s_nop 0
    v_add_f32_dpp v146, v20, v20 row_shl:4 row_mask:0xf bank_mask:0x5
    s_nop 1
    v_add_f32_dpp v146, v21, v21 row_shr:4 row_mask:0xf bank_mask:0xa
    s_nop 1
    v_add_f32_dpp v146, v146, v146 quad_perm:[1,0,3,2] row_mask:0xf bank_mask:0xf
    s_nop 1
    v_add_f32_dpp v146, v146, v146 quad_perm:[2,3,0,1] row_mask:0xf bank_mask:0xf
    v_cvt_pk_bf16_f32 v146, v146, v146
    v_lshlrev_b32 v146, 16, v146
    v_mul_f32 v146, s59, v146
    v_cvt_pk_bf16_f32 v146, v146, v146
    v_lshlrev_b32 v146, 16, v146
    s_waitcnt vmcnt(9)
    buffer_load_dwordx4 v[96:99], v1, s[28:31], s55 offen offset:0 nt
    buffer_load_dwordx4 a[92:95], v3, s[36:39], s54 offen offset:768 nt
    v_dot2_f32_bf16 v20, v128, v6, 0
    v_dot2_f32_bf16 v20, v129, v7, v20
    v_dot2_f32_bf16 v20, v130, v8, v20
    v_dot2_f32_bf16 v20, v131, v9, v20
    s_waitcnt vmcnt(9)
    buffer_load_dwordx4 v[100:103], v1, s[28:31], s55 offen offset:1024 nt
    v_dot2_f32_bf16 v21, v132, v6, 0
    v_dot2_f32_bf16 v21, v133, v7, v21
    v_dot2_f32_bf16 v21, v134, v8, v21
    v_dot2_f32_bf16 v21, v135, v9, v21
    s_waitcnt vmcnt(9)
    buffer_load_dwordx4 v[104:107], v1, s[28:31], s55 offen offset:2048 nt
    buffer_load_dwordx4 a[96:99], v3, s[36:39], s54 offen offset:1024 nt
    s_add_u32 s54, s54, 5120
    v_dot2_f32_bf16 v22, v136, v6, 0
    v_dot2_f32_bf16 v22, v137, v7, v22
    v_dot2_f32_bf16 v22, v138, v8, v22
    v_dot2_f32_bf16 v22, v139, v9, v22
    s_waitcnt vmcnt(9)
    buffer_load_dwordx4 v[108:111], v1, s[28:31], s55 offen offset:3072 nt
    s_add_u32 s55, s55, 32768
    v_dot2_f32_bf16 v23, v140, v6, 0
    v_dot2_f32_bf16 v23, v141, v7, v23
    v_dot2_f32_bf16 v23, v142, v8, v23
    v_dot2_f32_bf16 v23, v143, v9, v23
    v_add_f32_dpp v20, v20, v20 row_ror:8 row_mask:0xf bank_mask:0x3
    v_add_f32_dpp v21, v21, v21 row_ror:8 row_mask:0xf bank_mask:0x3
    s_nop 0
    v_add_f32_dpp v20, v22, v22 row_ror:8 row_mask:0xf bank_mask:0xc
    v_add_f32_dpp v21, v23, v23 row_ror:8 row_mask:0xf bank_mask:0xc
    s_nop 0
    v_add_f32_dpp v147, v20, v20 row_shl:4 row_mask:0xf bank_mask:0x5
    s_nop 1
    v_add_f32_dpp v147, v21, v21 row_shr:4 row_mask:0xf bank_mask:0xa
    s_nop 1
    v_add_f32_dpp v147, v147, v147 quad_perm:[1,0,3,2] row_mask:0xf bank_mask:0xf
    s_nop 1
    v_add_f32_dpp v147, v147, v147 quad_perm:[2,3,0,1] row_mask:0xf bank_mask:0xf
    v_cvt_pk_bf16_f32 v147, v147, v147
    v_lshlrev_b32 v147, 16, v147
    v_mul_f32 v147, s59, v147
    v_cvt_pk_bf16_f32 v147, v147, v147
    v_lshlrev_b32 v147, 16, v147
    v_max3_f32 v24, v144, v145, v146
    v_max_f32 v24, v24, v147
    s_nop 1
    v_max_f32_dpp v24, v24, v24 row_ror:4 row_mask:0xf bank_mask:0xf
    s_nop 1
    v_max_f32_dpp v24, v24, v24 row_ror:8 row_mask:0xf bank_mask:0xf
    v_max_f32 v24, v24, v10
    v_sub_f32 v26, v10, v24
    v_sub_f32 v144, v144, v24
    v_sub_f32 v145, v145, v24
    v_sub_f32 v146, v146, v24
    v_sub_f32 v147, v147, v24
    v_mul_f32 v26, 0x3fb8aa3b, v26
    v_mul_f32 v144, 0x3fb8aa3b, v144
    v_mul_f32 v145, 0x3fb8aa3b, v145
    v_mul_f32 v146, 0x3fb8aa3b, v146
    v_mul_f32 v147, 0x3fb8aa3b, v147
    v_exp_f32 v26, v26
    v_exp_f32 v144, v144
    v_exp_f32 v145, v145
    v_exp_f32 v146, v146
    v_exp_f32 v147, v147
    v_mov_b32 v10, v24
    v_pk_mul_f32 v[12:13], v[12:13], v[26:27] op_sel_hi:[1,0]
    v_pk_mul_f32 v[14:15], v[14:15], v[26:27] op_sel_hi:[1,0]
    v_pk_mul_f32 v[16:17], v[16:17], v[26:27] op_sel_hi:[1,0]
    v_pk_mul_f32 v[18:19], v[18:19], v[26:27] op_sel_hi:[1,0]
    v_fma_f32 v11, v11, v26, v144
    v_cvt_pk_bf16_f32 v25, v144, v144
    v_and_b32 v152, v25, v4
    v_and_b32 v153, v25, v5
    v_cvt_pk_bf16_f32 v25, v145, v145
    v_add_f32 v11, v11, v145
    v_and_b32 v154, v25, v4
    v_and_b32 v155, v25, v5
    v_cvt_pk_bf16_f32 v25, v146, v146
    v_add_f32 v11, v11, v146
    v_and_b32 v156, v25, v4
    v_and_b32 v157, v25, v5
    v_cvt_pk_bf16_f32 v25, v147, v147
    v_add_f32 v11, v11, v147
    v_and_b32 v158, v25, v4
    v_and_b32 v159, v25, v5
    s_waitcnt vmcnt(8)
    buffer_load_dwordx4 v[112:115], v1, s[28:31], s55 offen offset:0 nt
    buffer_load_dwordx4 a[100:103], v3, s[36:39], s54 offen offset:0 nt
    v_mfma_f32_4x4x4_16b_bf16 v[12:15], v[152:153], v[80:81], v[12:15] cbsz:2 abid:0
    v_mfma_f32_4x4x4_16b_bf16 v[16:19], v[152:153], v[82:83], v[16:19] cbsz:2 abid:0
    s_waitcnt vmcnt(9)
    buffer_load_dwordx4 v[116:119], v1, s[28:31], s55 offen offset:1024 nt
    buffer_load_dwordx4 a[104:107], v3, s[36:39], s54 offen offset:256 nt
    v_mfma_f32_4x4x4_16b_bf16 v[12:15], v[152:153], v[84:85], v[12:15] cbsz:2 abid:1
    v_mfma_f32_4x4x4_16b_bf16 v[16:19], v[152:153], v[86:87], v[16:19] cbsz:2 abid:1
    s_waitcnt vmcnt(9)
    buffer_load_dwordx4 v[120:123], v1, s[28:31], s55 offen offset:2048 nt
    v_mfma_f32_4x4x4_16b_bf16 v[12:15], v[152:153], v[88:89], v[12:15] cbsz:2 abid:2
    v_mfma_f32_4x4x4_16b_bf16 v[16:19], v[152:153], v[90:91], v[16:19] cbsz:2 abid:2
    s_waitcnt vmcnt(8)
    buffer_load_dwordx4 v[124:127], v1, s[28:31], s55 offen offset:3072 nt
    s_add_u32 s55, s55, 32768
    buffer_load_dwordx4 a[108:111], v3, s[36:39], s54 offen offset:512 nt
    v_mfma_f32_4x4x4_16b_bf16 v[12:15], v[152:153], v[92:93], v[12:15] cbsz:2 abid:3
    v_mfma_f32_4x4x4_16b_bf16 v[16:19], v[152:153], v[94:95], v[16:19] cbsz:2 abid:3
    s_waitcnt vmcnt(9)
    buffer_load_dwordx4 v[128:131], v1, s[28:31], s55 offen offset:0 nt
    buffer_load_dwordx4 a[112:115], v3, s[36:39], s54 offen offset:768 nt
    v_mfma_f32_4x4x4_16b_bf16 v[12:15], v[154:155], v[96:97], v[12:15] cbsz:2 abid:0
    v_mfma_f32_4x4x4_16b_bf16 v[16:19], v[154:155], v[98:99], v[16:19] cbsz:2 abid:0
    s_waitcnt vmcnt(9)
    buffer_load_dwordx4 v[132:135], v1, s[28:31], s55 offen offset:1024 nt
    v_mfma_f32_4x4x4_16b_bf16 v[12:15], v[154:155], v[100:101], v[12:15] cbsz:2 abid:1
    v_mfma_f32_4x4x4_16b_bf16 v[16:19], v[154:155], v[102:103], v[16:19] cbsz:2 abid:1
    s_waitcnt vmcnt(9)
    buffer_load_dwordx4 v[136:139], v1, s[28:31], s55 offen offset:2048 nt
    buffer_load_dwordx4 a[116:119], v3, s[36:39], s54 offen offset:1024 nt
    s_add_u32 s54, s54, 5120
    v_mfma_f32_4x4x4_16b_bf16 v[12:15], v[154:155], v[104:105], v[12:15] cbsz:2 abid:2
    v_mfma_f32_4x4x4_16b_bf16 v[16:19], v[154:155], v[106:107], v[16:19] cbsz:2 abid:2
    s_waitcnt vmcnt(9)
    buffer_load_dwordx4 v[140:143], v1, s[28:31], s55 offen offset:3072 nt
    s_add_u32 s55, s55, 32768
    s_cmp_ge_u32 s55, 0x100000
    s_cselect_b32 s7, 1032192, 0
    s_sub_u32 s55, s55, s7
    v_mfma_f32_4x4x4_16b_bf16 v[12:15], v[154:155], v[108:109], v[12:15] cbsz:2 abid:3
    v_mfma_f32_4x4x4_16b_bf16 v[16:19], v[154:155], v[110:111], v[16:19] cbsz:2 abid:3
    s_mov_b32 s63, 0
    s_mov_b32 s57, 15
    s_xor_b32 s7, s62, 1
    s_mul_i32 s65, s7, 2560
    s_xor_b32 s7, s62, 2
    s_mul_i32 s66, s7, 2560
    s_xor_b32 s7, s62, 3
    s_mul_i32 s67, s7, 2560
    s_xor_b32 s7, s62, 4
    s_mul_i32 s68, s7, 2560
    s_xor_b32 s7, s62, 5
    s_mul_i32 s69, s7, 2560
    s_xor_b32 s7, s62, 6
    s_mul_i32 s70, s7, 2560
    s_xor_b32 s7, s62, 7
    s_mul_i32 s71, s7, 2560
    s_xor_b32 s7, s62, 8
    s_mul_i32 s72, s7, 2560
    s_xor_b32 s7, s62, 9
    s_mul_i32 s73, s7, 2560
    s_xor_b32 s7, s62, 10
    s_mul_i32 s74, s7, 2560
    s_xor_b32 s7, s62, 11
    s_mul_i32 s75, s7, 2560
    s_xor_b32 s7, s62, 12
    s_mul_i32 s76, s7, 2560
    s_xor_b32 s7, s62, 13
    s_mul_i32 s77, s7, 2560
    s_xor_b32 s7, s62, 14
    s_mul_i32 s78, s7, 2560
    s_xor_b32 s7, s62, 15
    s_mul_i32 s79, s7, 2560
    s_xor_b32 s7, s62, 16
    s_mul_i32 s80, s7, 2560
    s_xor_b32 s7, s62, 17
    s_mul_i32 s81, s7, 2560
    s_xor_b32 s7, s62, 18
    s_mul_i32 s82, s7, 2560
    s_xor_b32 s7, s62, 19
    s_mul_i32 s83, s7, 2560
    s_xor_b32 s7, s62, 20
    s_mul_i32 s84, s7, 2560
    s_xor_b32 s7, s62, 21
    s_mul_i32 s85, s7, 2560
    s_xor_b32 s7, s62, 22
    s_mul_i32 s86, s7, 2560
    s_xor_b32 s7, s62, 23
    s_mul_i32 s87, s7, 2560
    s_xor_b32 s7, s62, 24
    s_mul_i32 s88, s7, 2560
    s_xor_b32 s7, s62, 25
    s_mul_i32 s89, s7, 2560
    s_xor_b32 s7, s62, 26
    s_mul_i32 s90, s7, 2560
    s_xor_b32 s7, s62, 27
    s_mul_i32 s91, s7, 2560
    s_xor_b32 s7, s62, 28
    s_mul_i32 s92, s7, 2560
    s_xor_b32 s7, s62, 29
    s_mul_i32 s93, s7, 2560
    s_xor_b32 s7, s62, 30
    s_mul_i32 s94, s7, 2560
    s_xor_b32 s7, s62, 31
    s_mul_i32 s95, s7, 2560
    s_add_u32 s63, s63, 13
    s_mov_b32 s60, 1
    s_mov_b32 s52, -1
    s_mov_b32 s53, 0
    s_sub_u32 s63, s63, 5
.p2align 3
L_loopp:
    s_waitcnt vmcnt(4)
    buffer_load_dwordx4 v[80:83], v1, s[24:27], s56 offen offset:0 nt
    v_mfma_f32_4x4x4_16b_bf16 v[12:15], v[156:157], v[112:113], v[12:15] cbsz:2 abid:0
    v_mfma_f32_4x4x4_16b_bf16 v[16:19], v[156:157], v[114:115], v[16:19] cbsz:2 abid:0
    s_waitcnt vmcnt(4)
    buffer_load_dwordx4 v[84:87], v1, s[24:27], s56 offen offset:1024 nt
    v_mfma_f32_4x4x4_16b_bf16 v[12:15], v[156:157], v[116:117], v[12:15] cbsz:2 abid:1
    v_mfma_f32_4x4x4_16b_bf16 v[16:19], v[156:157], v[118:119], v[16:19] cbsz:2 abid:1
    s_waitcnt vmcnt(4)
    buffer_load_dwordx4 v[88:91], v1, s[24:27], s56 offen offset:2048 nt
    v_mfma_f32_4x4x4_16b_bf16 v[12:15], v[156:157], v[120:121], v[12:15] cbsz:2 abid:2
    v_mfma_f32_4x4x4_16b_bf16 v[16:19], v[156:157], v[122:123], v[16:19] cbsz:2 abid:2
    s_waitcnt vmcnt(4)
    buffer_load_dwordx4 v[92:95], v1, s[24:27], s56 offen offset:3072 nt
    s_add_u32 s56, s56, 32768
    v_mfma_f32_4x4x4_16b_bf16 v[12:15], v[156:157], v[124:125], v[12:15] cbsz:2 abid:3
    v_mfma_f32_4x4x4_16b_bf16 v[16:19], v[156:157], v[126:127], v[16:19] cbsz:2 abid:3
    s_waitcnt vmcnt(4)
    buffer_load_dwordx4 v[96:99], v1, s[24:27], s56 offen offset:0 nt
    v_mfma_f32_4x4x4_16b_bf16 v[12:15], v[158:159], v[128:129], v[12:15] cbsz:2 abid:0
    v_mfma_f32_4x4x4_16b_bf16 v[16:19], v[158:159], v[130:131], v[16:19] cbsz:2 abid:0
    s_waitcnt vmcnt(4)
    buffer_load_dwordx4 v[100:103], v1, s[24:27], s56 offen offset:1024 nt
    v_mfma_f32_4x4x4_16b_bf16 v[12:15], v[158:159], v[132:133], v[12:15] cbsz:2 abid:1
    v_mfma_f32_4x4x4_16b_bf16 v[16:19], v[158:159], v[134:135], v[16:19] cbsz:2 abid:1
    s_waitcnt vmcnt(4)
    buffer_load_dwordx4 v[104:107], v1, s[24:27], s56 offen offset:2048 nt
    v_mfma_f32_4x4x4_16b_bf16 v[12:15], v[158:159], v[136:137], v[12:15] cbsz:2 abid:2
    v_mfma_f32_4x4x4_16b_bf16 v[16:19], v[158:159], v[138:139], v[16:19] cbsz:2 abid:2
    s_waitcnt vmcnt(4)
    buffer_load_dwordx4 v[108:111], v1, s[24:27], s56 offen offset:3072 nt
    s_add_u32 s56, s56, 32768
    v_mfma_f32_4x4x4_16b_bf16 v[12:15], v[158:159], v[140:141], v[12:15] cbsz:2 abid:3
    v_mfma_f32_4x4x4_16b_bf16 v[16:19], v[158:159], v[142:143], v[16:19] cbsz:2 abid:3
    s_waitcnt vmcnt(4)
    buffer_load_dwordx4 v[112:115], v1, s[24:27], s56 offen offset:0 nt
    v_dot2_f32_bf16 v20, v80, v6, 0
    v_dot2_f32_bf16 v20, v81, v7, v20
    v_dot2_f32_bf16 v20, v82, v8, v20
    v_dot2_f32_bf16 v20, v83, v9, v20
    s_waitcnt vmcnt(4)
    buffer_load_dwordx4 v[116:119], v1, s[24:27], s56 offen offset:1024 nt
    v_dot2_f32_bf16 v21, v84, v6, 0
    v_dot2_f32_bf16 v21, v85, v7, v21
    v_dot2_f32_bf16 v21, v86, v8, v21
    v_dot2_f32_bf16 v21, v87, v9, v21
    s_waitcnt vmcnt(4)
    buffer_load_dwordx4 v[120:123], v1, s[24:27], s56 offen offset:2048 nt
    v_dot2_f32_bf16 v22, v88, v6, 0
    v_dot2_f32_bf16 v22, v89, v7, v22
    v_dot2_f32_bf16 v22, v90, v8, v22
    v_dot2_f32_bf16 v22, v91, v9, v22
    s_waitcnt vmcnt(4)
    buffer_load_dwordx4 v[124:127], v1, s[24:27], s56 offen offset:3072 nt
    s_add_u32 s56, s56, 32768
    v_dot2_f32_bf16 v23, v92, v6, 0
    v_dot2_f32_bf16 v23, v93, v7, v23
    v_dot2_f32_bf16 v23, v94, v8, v23
    v_dot2_f32_bf16 v23, v95, v9, v23
    v_add_f32_dpp v20, v20, v20 row_ror:8 row_mask:0xf bank_mask:0x3
    v_add_f32_dpp v21, v21, v21 row_ror:8 row_mask:0xf bank_mask:0x3
    s_nop 0
    v_add_f32_dpp v20, v22, v22 row_ror:8 row_mask:0xf bank_mask:0xc
    v_add_f32_dpp v21, v23, v23 row_ror:8 row_mask:0xf bank_mask:0xc
    s_nop 0
    v_add_f32_dpp v144, v20, v20 row_shl:4 row_mask:0xf bank_mask:0x5
    s_nop 1
    v_add_f32_dpp v144, v21, v21 row_shr:4 row_mask:0xf bank_mask:0xa
    s_nop 1
    v_add_f32_dpp v144, v144, v144 quad_perm:[1,0,3,2] row_mask:0xf bank_mask:0xf
    s_nop 1
    v_add_f32_dpp v144, v144, v144 quad_perm:[2,3,0,1] row_mask:0xf bank_mask:0xf
    v_cvt_pk_bf16_f32 v144, v144, v144
    v_lshlrev_b32 v144, 16, v144
    v_mul_f32 v144, s59, v144
    v_cvt_pk_bf16_f32 v144, v144, v144
    v_lshlrev_b32 v144, 16, v144
    s_waitcnt vmcnt(4)
    buffer_load_dwordx4 v[128:131], v1, s[24:27], s56 offen offset:0 nt
    v_dot2_f32_bf16 v20, v96, v6, 0
    v_dot2_f32_bf16 v20, v97, v7, v20
    v_dot2_f32_bf16 v20, v98, v8, v20
    v_dot2_f32_bf16 v20, v99, v9, v20
    s_waitcnt vmcnt(4)
    buffer_load_dwordx4 v[132:135], v1, s[24:27], s56 offen offset:1024 nt
    v_dot2_f32_bf16 v21, v100, v6, 0
    v_dot2_f32_bf16 v21, v101, v7, v21
    v_dot2_f32_bf16 v21, v102, v8, v21
    v_dot2_f32_bf16 v21, v103, v9, v21
    s_waitcnt vmcnt(4)
    buffer_load_dwordx4 v[136:139], v1, s[24:27], s56 offen offset:2048 nt
    v_dot2_f32_bf16 v22, v104, v6, 0
    v_dot2_f32_bf16 v22, v105, v7, v22
    v_dot2_f32_bf16 v22, v106, v8, v22
    v_dot2_f32_bf16 v22, v107, v9, v22
    s_waitcnt vmcnt(4)
    buffer_load_dwordx4 v[140:143], v1, s[24:27], s56 offen offset:3072 nt
    s_add_u32 s56, s56, 32768
    s_cmp_ge_u32 s56, 0x100000
    s_cselect_b32 s7, 1032192, 0
    s_sub_u32 s56, s56, s7
    v_dot2_f32_bf16 v23, v108, v6, 0
    v_dot2_f32_bf16 v23, v109, v7, v23
    v_dot2_f32_bf16 v23, v110, v8, v23
    v_dot2_f32_bf16 v23, v111, v9, v23
    v_add_f32_dpp v20, v20, v20 row_ror:8 row_mask:0xf bank_mask:0x3
    v_add_f32_dpp v21, v21, v21 row_ror:8 row_mask:0xf bank_mask:0x3
    s_nop 0
    v_add_f32_dpp v20, v22, v22 row_ror:8 row_mask:0xf bank_mask:0xc
    v_add_f32_dpp v21, v23, v23 row_ror:8 row_mask:0xf bank_mask:0xc
    s_nop 0
    v_add_f32_dpp v145, v20, v20 row_shl:4 row_mask:0xf bank_mask:0x5
    s_nop 1
    v_add_f32_dpp v145, v21, v21 row_shr:4 row_mask:0xf bank_mask:0xa
    s_nop 1
    v_add_f32_dpp v145, v145, v145 quad_perm:[1,0,3,2] row_mask:0xf bank_mask:0xf
    s_nop 1
    v_add_f32_dpp v145, v145, v145 quad_perm:[2,3,0,1] row_mask:0xf bank_mask:0xf
    v_cvt_pk_bf16_f32 v145, v145, v145
    v_lshlrev_b32 v145, 16, v145
    v_mul_f32 v145, s59, v145
    v_cvt_pk_bf16_f32 v145, v145, v145
    v_lshlrev_b32 v145, 16, v145
    s_waitcnt vmcnt(4)
    buffer_load_dwordx4 v[80:83], v1, s[28:31], s55 offen offset:0 nt
    v_dot2_f32_bf16 v20, v112, v6, 0
    v_dot2_f32_bf16 v20, v113, v7, v20
    v_dot2_f32_bf16 v20, v114, v8, v20
    v_dot2_f32_bf16 v20, v115, v9, v20
    s_waitcnt vmcnt(4)
    buffer_load_dwordx4 v[84:87], v1, s[28:31], s55 offen offset:1024 nt
    v_dot2_f32_bf16 v21, v116, v6, 0
    v_dot2_f32_bf16 v21, v117, v7, v21
    v_dot2_f32_bf16 v21, v118, v8, v21
    v_dot2_f32_bf16 v21, v119, v9, v21
    s_waitcnt vmcnt(4)
    buffer_load_dwordx4 v[88:91], v1, s[28:31], s55 offen offset:2048 nt
    v_dot2_f32_bf16 v22, v120, v6, 0
    v_dot2_f32_bf16 v22, v121, v7, v22
    v_dot2_f32_bf16 v22, v122, v8, v22
    v_dot2_f32_bf16 v22, v123, v9, v22
    s_waitcnt vmcnt(4)
    buffer_load_dwordx4 v[92:95], v1, s[28:31], s55 offen offset:3072 nt
    s_add_u32 s55, s55, 32768
    v_dot2_f32_bf16 v23, v124, v6, 0
    v_dot2_f32_bf16 v23, v125, v7, v23
    v_dot2_f32_bf16 v23, v126, v8, v23
    v_dot2_f32_bf16 v23, v127, v9, v23
    v_add_f32_dpp v20, v20, v20 row_ror:8 row_mask:0xf bank_mask:0x3
    v_add_f32_dpp v21, v21, v21 row_ror:8 row_mask:0xf bank_mask:0x3
    s_nop 0
    v_add_f32_dpp v20, v22, v22 row_ror:8 row_mask:0xf bank_mask:0xc
    v_add_f32_dpp v21, v23, v23 row_ror:8 row_mask:0xf bank_mask:0xc
    s_nop 0
    v_add_f32_dpp v146, v20, v20 row_shl:4 row_mask:0xf bank_mask:0x5
    s_nop 1
    v_add_f32_dpp v146, v21, v21 row_shr:4 row_mask:0xf bank_mask:0xa
    s_nop 1
    v_add_f32_dpp v146, v146, v146 quad_perm:[1,0,3,2] row_mask:0xf bank_mask:0xf
    s_nop 1
    v_add_f32_dpp v146, v146, v146 quad_perm:[2,3,0,1] row_mask:0xf bank_mask:0xf
    v_cvt_pk_bf16_f32 v146, v146, v146
    v_lshlrev_b32 v146, 16, v146
    v_mul_f32 v146, s59, v146
    v_cvt_pk_bf16_f32 v146, v146, v146
    v_lshlrev_b32 v146, 16, v146
    s_waitcnt vmcnt(4)
    buffer_load_dwordx4 v[96:99], v1, s[28:31], s55 offen offset:0 nt
    v_dot2_f32_bf16 v20, v128, v6, 0
    v_dot2_f32_bf16 v20, v129, v7, v20
    v_dot2_f32_bf16 v20, v130, v8, v20
    v_dot2_f32_bf16 v20, v131, v9, v20
    s_waitcnt vmcnt(4)
    buffer_load_dwordx4 v[100:103], v1, s[28:31], s55 offen offset:1024 nt
    v_dot2_f32_bf16 v21, v132, v6, 0
    v_dot2_f32_bf16 v21, v133, v7, v21
    v_dot2_f32_bf16 v21, v134, v8, v21
    v_dot2_f32_bf16 v21, v135, v9, v21
    s_waitcnt vmcnt(4)
    buffer_load_dwordx4 v[104:107], v1, s[28:31], s55 offen offset:2048 nt
    v_dot2_f32_bf16 v22, v136, v6, 0
    v_dot2_f32_bf16 v22, v137, v7, v22
    v_dot2_f32_bf16 v22, v138, v8, v22
    v_dot2_f32_bf16 v22, v139, v9, v22
    s_waitcnt vmcnt(4)
    buffer_load_dwordx4 v[108:111], v1, s[28:31], s55 offen offset:3072 nt
    s_add_u32 s55, s55, 32768
    v_dot2_f32_bf16 v23, v140, v6, 0
    v_dot2_f32_bf16 v23, v141, v7, v23
    v_dot2_f32_bf16 v23, v142, v8, v23
    v_dot2_f32_bf16 v23, v143, v9, v23
    v_add_f32_dpp v20, v20, v20 row_ror:8 row_mask:0xf bank_mask:0x3
    v_add_f32_dpp v21, v21, v21 row_ror:8 row_mask:0xf bank_mask:0x3
    s_nop 0
    v_add_f32_dpp v20, v22, v22 row_ror:8 row_mask:0xf bank_mask:0xc
    v_add_f32_dpp v21, v23, v23 row_ror:8 row_mask:0xf bank_mask:0xc
    s_nop 0
    v_add_f32_dpp v147, v20, v20 row_shl:4 row_mask:0xf bank_mask:0x5
    s_nop 1
    v_add_f32_dpp v147, v21, v21 row_shr:4 row_mask:0xf bank_mask:0xa
    s_nop 1
    v_add_f32_dpp v147, v147, v147 quad_perm:[1,0,3,2] row_mask:0xf bank_mask:0xf
    s_nop 1
    v_add_f32_dpp v147, v147, v147 quad_perm:[2,3,0,1] row_mask:0xf bank_mask:0xf
    v_cvt_pk_bf16_f32 v147, v147, v147
    v_lshlrev_b32 v147, 16, v147
    v_mul_f32 v147, s59, v147
    v_cvt_pk_bf16_f32 v147, v147, v147
    v_lshlrev_b32 v147, 16, v147
    v_max3_f32 v24, v144, v145, v146
    v_max_f32 v24, v24, v147
    s_nop 1
    v_max_f32_dpp v24, v24, v24 row_ror:4 row_mask:0xf bank_mask:0xf
    s_nop 1
    v_max_f32_dpp v24, v24, v24 row_ror:8 row_mask:0xf bank_mask:0xf
    v_max_f32 v24, v24, v10
    v_sub_f32 v26, v10, v24
    v_sub_f32 v144, v144, v24
    v_sub_f32 v145, v145, v24
    v_sub_f32 v146, v146, v24
    v_sub_f32 v147, v147, v24
    v_mul_f32 v26, 0x3fb8aa3b, v26
    v_mul_f32 v144, 0x3fb8aa3b, v144
    v_mul_f32 v145, 0x3fb8aa3b, v145
    v_mul_f32 v146, 0x3fb8aa3b, v146
    v_mul_f32 v147, 0x3fb8aa3b, v147
    v_exp_f32 v26, v26
    v_exp_f32 v144, v144
    v_exp_f32 v145, v145
    v_exp_f32 v146, v146
    v_exp_f32 v147, v147
    v_mov_b32 v10, v24
    v_pk_mul_f32 v[12:13], v[12:13], v[26:27] op_sel_hi:[1,0]
    v_pk_mul_f32 v[14:15], v[14:15], v[26:27] op_sel_hi:[1,0]
    v_pk_mul_f32 v[16:17], v[16:17], v[26:27] op_sel_hi:[1,0]
    v_pk_mul_f32 v[18:19], v[18:19], v[26:27] op_sel_hi:[1,0]
    v_fma_f32 v11, v11, v26, v144
    v_cvt_pk_bf16_f32 v25, v144, v144
    v_and_b32 v152, v25, v4
    v_and_b32 v153, v25, v5
    v_cvt_pk_bf16_f32 v25, v145, v145
    v_add_f32 v11, v11, v145
    v_and_b32 v154, v25, v4
    v_and_b32 v155, v25, v5
    v_cvt_pk_bf16_f32 v25, v146, v146
    v_add_f32 v11, v11, v146
    v_and_b32 v156, v25, v4
    v_and_b32 v157, v25, v5
    v_cvt_pk_bf16_f32 v25, v147, v147
    v_add_f32 v11, v11, v147
    v_and_b32 v158, v25, v4
    v_and_b32 v159, v25, v5
    s_waitcnt vmcnt(4)
    buffer_load_dwordx4 v[112:115], v1, s[28:31], s55 offen offset:0 nt
    v_mfma_f32_4x4x4_16b_bf16 v[12:15], v[152:153], v[80:81], v[12:15] cbsz:2 abid:0
    v_mfma_f32_4x4x4_16b_bf16 v[16:19], v[152:153], v[82:83], v[16:19] cbsz:2 abid:0
    s_waitcnt vmcnt(4)
    buffer_load_dwordx4 v[116:119], v1, s[28:31], s55 offen offset:1024 nt
    v_mfma_f32_4x4x4_16b_bf16 v[12:15], v[152:153], v[84:85], v[12:15] cbsz:2 abid:1
    v_mfma_f32_4x4x4_16b_bf16 v[16:19], v[152:153], v[86:87], v[16:19] cbsz:2 abid:1
    s_waitcnt vmcnt(4)
    buffer_load_dwordx4 v[120:123], v1, s[28:31], s55 offen offset:2048 nt
    v_mfma_f32_4x4x4_16b_bf16 v[12:15], v[152:153], v[88:89], v[12:15] cbsz:2 abid:2
    v_mfma_f32_4x4x4_16b_bf16 v[16:19], v[152:153], v[90:91], v[16:19] cbsz:2 abid:2
    s_waitcnt vmcnt(4)
    buffer_load_dwordx4 v[124:127], v1, s[28:31], s55 offen offset:3072 nt
    s_add_u32 s55, s55, 32768
    v_mfma_f32_4x4x4_16b_bf16 v[12:15], v[152:153], v[92:93], v[12:15] cbsz:2 abid:3
    v_mfma_f32_4x4x4_16b_bf16 v[16:19], v[152:153], v[94:95], v[16:19] cbsz:2 abid:3
    s_waitcnt vmcnt(4)
    buffer_load_dwordx4 v[128:131], v1, s[28:31], s55 offen offset:0 nt
    v_mfma_f32_4x4x4_16b_bf16 v[12:15], v[154:155], v[96:97], v[12:15] cbsz:2 abid:0
    v_mfma_f32_4x4x4_16b_bf16 v[16:19], v[154:155], v[98:99], v[16:19] cbsz:2 abid:0
    s_waitcnt vmcnt(4)
    buffer_load_dwordx4 v[132:135], v1, s[28:31], s55 offen offset:1024 nt
    v_mfma_f32_4x4x4_16b_bf16 v[12:15], v[154:155], v[100:101], v[12:15] cbsz:2 abid:1
    v_mfma_f32_4x4x4_16b_bf16 v[16:19], v[154:155], v[102:103], v[16:19] cbsz:2 abid:1
    s_waitcnt vmcnt(4)
    buffer_load_dwordx4 v[136:139], v1, s[28:31], s55 offen offset:2048 nt
    v_mfma_f32_4x4x4_16b_bf16 v[12:15], v[154:155], v[104:105], v[12:15] cbsz:2 abid:2
    v_mfma_f32_4x4x4_16b_bf16 v[16:19], v[154:155], v[106:107], v[16:19] cbsz:2 abid:2
    s_waitcnt vmcnt(4)
    buffer_load_dwordx4 v[140:143], v1, s[28:31], s55 offen offset:3072 nt
    s_add_u32 s55, s55, 32768
    s_cmp_ge_u32 s55, 0x100000
    s_cselect_b32 s7, 1032192, 0
    s_sub_u32 s55, s55, s7
    v_mfma_f32_4x4x4_16b_bf16 v[12:15], v[154:155], v[108:109], v[12:15] cbsz:2 abid:3
    v_mfma_f32_4x4x4_16b_bf16 v[16:19], v[154:155], v[110:111], v[16:19] cbsz:2 abid:3
    s_sub_u32 s63, s63, 1
    s_cmp_lg_u32 s63, 0
    s_cbranch_scc1 L_loopp
    s_mov_b32 s63, 5
    s_mov_b32 s57, 79
.p2align 3
L_loop:
    s_waitcnt vmcnt(7)
    s_bitcmp1_b32 s52, 0
    s_cbranch_scc0 L_w0
    s_waitcnt vmcnt(5)
    s_bitcmp1_b32 s53, 0
    s_cbranch_scc0 L_w0
    s_waitcnt vmcnt(4)
L_w0:
    buffer_load_dwordx4 v[80:83], v1, s[24:27], s56 offen offset:0 nt
    s_add_u32 s57, s57, 1
    v_mov_b32 v170, s57
    buffer_store_dword v170, v168, s[8:11], 0 offen
    v_mfma_f32_4x4x4_16b_bf16 v[12:15], v[156:157], v[112:113], v[12:15] cbsz:2 abid:0
    v_mfma_f32_4x4x4_16b_bf16 v[16:19], v[156:157], v[114:115], v[16:19] cbsz:2 abid:0
    s_waitcnt vmcnt(7)
    s_bitcmp1_b32 s52, 1
    s_cbranch_scc0 L_w1
    s_waitcnt vmcnt(6)
    s_bitcmp1_b32 s53, 1
    s_cbranch_scc0 L_w1
    s_waitcnt vmcnt(4)
L_w1:
    buffer_load_dwordx4 v[84:87], v1, s[24:27], s56 offen offset:1024 nt
    v_mfma_f32_4x4x4_16b_bf16 v[12:15], v[156:157], v[116:117], v[12:15] cbsz:2 abid:1
    v_mfma_f32_4x4x4_16b_bf16 v[16:19], v[156:157], v[118:119], v[16:19] cbsz:2 abid:1
    s_waitcnt vmcnt(7)
    s_bitcmp1_b32 s52, 2
    s_cbranch_scc0 L_w2
    s_waitcnt vmcnt(5)
    s_bitcmp1_b32 s53, 2
    s_cbranch_scc0 L_w2
    s_waitcnt vmcnt(4)
L_w2:
    buffer_load_dwordx4 v[88:91], v1, s[24:27], s56 offen offset:2048 nt
    v_mfma_f32_4x4x4_16b_bf16 v[12:15], v[156:157], v[120:121], v[12:15] cbsz:2 abid:2
    v_mfma_f32_4x4x4_16b_bf16 v[16:19], v[156:157], v[122:123], v[16:19] cbsz:2 abid:2
    s_waitcnt vmcnt(7)
    s_bitcmp1_b32 s52, 3
    s_cbranch_scc0 L_w3
    s_waitcnt vmcnt(5)
    s_bitcmp1_b32 s53, 3
    s_cbranch_scc0 L_w3
    s_waitcnt vmcnt(4)
L_w3:
    buffer_load_dwordx4 v[92:95], v1, s[24:27], s56 offen offset:3072 nt
    s_add_u32 s56, s56, 32768
    v_mfma_f32_4x4x4_16b_bf16 v[12:15], v[156:157], v[124:125], v[12:15] cbsz:2 abid:3
    v_mfma_f32_4x4x4_16b_bf16 v[16:19], v[156:157], v[126:127], v[16:19] cbsz:2 abid:3
    s_waitcnt vmcnt(7)
    s_bitcmp1_b32 s52, 4
    s_cbranch_scc0 L_w4
    s_waitcnt vmcnt(5)
    s_bitcmp1_b32 s53, 4
    s_cbranch_scc0 L_w4
    s_waitcnt vmcnt(4)
L_w4:
    buffer_load_dwordx4 v[96:99], v1, s[24:27], s56 offen offset:0 nt
    s_add_u32 s57, s57, 1
    v_mov_b32 v170, s57
    buffer_store_dword v170, v168, s[8:11], 0 offen
    v_mfma_f32_4x4x4_16b_bf16 v[12:15], v[158:159], v[128:129], v[12:15] cbsz:2 abid:0
    v_mfma_f32_4x4x4_16b_bf16 v[16:19], v[158:159], v[130:131], v[16:19] cbsz:2 abid:0
    s_waitcnt vmcnt(7)
    s_bitcmp1_b32 s52, 5
    s_cbranch_scc0 L_w5
    s_waitcnt vmcnt(6)
    s_bitcmp1_b32 s53, 5
    s_cbranch_scc0 L_w5
    s_waitcnt vmcnt(4)
L_w5:
    buffer_load_dwordx4 v[100:103], v1, s[24:27], s56 offen offset:1024 nt
    v_mfma_f32_4x4x4_16b_bf16 v[12:15], v[158:159], v[132:133], v[12:15] cbsz:2 abid:1
    v_mfma_f32_4x4x4_16b_bf16 v[16:19], v[158:159], v[134:135], v[16:19] cbsz:2 abid:1
    s_waitcnt vmcnt(7)
    s_bitcmp1_b32 s52, 6
    s_cbranch_scc0 L_w6
    s_waitcnt vmcnt(5)
    s_bitcmp1_b32 s53, 6
    s_cbranch_scc0 L_w6
    s_waitcnt vmcnt(4)
L_w6:
    buffer_load_dwordx4 v[104:107], v1, s[24:27], s56 offen offset:2048 nt
    v_mfma_f32_4x4x4_16b_bf16 v[12:15], v[158:159], v[136:137], v[12:15] cbsz:2 abid:2
    v_mfma_f32_4x4x4_16b_bf16 v[16:19], v[158:159], v[138:139], v[16:19] cbsz:2 abid:2
    s_waitcnt vmcnt(7)
    s_bitcmp1_b32 s52, 7
    s_cbranch_scc0 L_w7
    s_waitcnt vmcnt(5)
    s_bitcmp1_b32 s53, 7
    s_cbranch_scc0 L_w7
    s_waitcnt vmcnt(4)
L_w7:
    buffer_load_dwordx4 v[108:111], v1, s[24:27], s56 offen offset:3072 nt
    s_add_u32 s56, s56, 32768
    v_mfma_f32_4x4x4_16b_bf16 v[12:15], v[158:159], v[140:141], v[12:15] cbsz:2 abid:3
    v_mfma_f32_4x4x4_16b_bf16 v[16:19], v[158:159], v[142:143], v[16:19] cbsz:2 abid:3
    s_waitcnt vmcnt(7)
    s_bitcmp1_b32 s52, 8
    s_cbranch_scc0 L_w8
    s_waitcnt vmcnt(5)
    s_bitcmp1_b32 s53, 8
    s_cbranch_scc0 L_w8
    s_waitcnt vmcnt(4)
L_w8:
    buffer_load_dwordx4 v[112:115], v1, s[24:27], s56 offen offset:0 nt
    s_add_u32 s57, s57, 1
    v_mov_b32 v170, s57
    buffer_store_dword v170, v168, s[8:11], 0 offen
    v_dot2_f32_bf16 v20, v80, v6, 0
    v_dot2_f32_bf16 v20, v81, v7, v20
    v_dot2_f32_bf16 v20, v82, v8, v20
    v_dot2_f32_bf16 v20, v83, v9, v20
    s_waitcnt vmcnt(7)
    s_bitcmp1_b32 s52, 9
    s_cbranch_scc0 L_w9
    s_waitcnt vmcnt(6)
    s_bitcmp1_b32 s53, 9
    s_cbranch_scc0 L_w9
    s_waitcnt vmcnt(4)
L_w9:
    buffer_load_dwordx4 v[116:119], v1, s[24:27], s56 offen offset:1024 nt
    v_dot2_f32_bf16 v21, v84, v6, 0
    v_dot2_f32_bf16 v21, v85, v7, v21
    v_dot2_f32_bf16 v21, v86, v8, v21
    v_dot2_f32_bf16 v21, v87, v9, v21
    s_waitcnt vmcnt(7)
    s_bitcmp1_b32 s52, 10
    s_cbranch_scc0 L_w10
    s_waitcnt vmcnt(5)
    s_bitcmp1_b32 s53, 10
    s_cbranch_scc0 L_w10
    s_waitcnt vmcnt(4)
L_w10:
    buffer_load_dwordx4 v[120:123], v1, s[24:27], s56 offen offset:2048 nt
    v_dot2_f32_bf16 v22, v88, v6, 0
    v_dot2_f32_bf16 v22, v89, v7, v22
    v_dot2_f32_bf16 v22, v90, v8, v22
    v_dot2_f32_bf16 v22, v91, v9, v22
    s_waitcnt vmcnt(7)
    s_bitcmp1_b32 s52, 11
    s_cbranch_scc0 L_w11
    s_waitcnt vmcnt(5)
    s_bitcmp1_b32 s53, 11
    s_cbranch_scc0 L_w11
    s_waitcnt vmcnt(4)
L_w11:
    buffer_load_dwordx4 v[124:127], v1, s[24:27], s56 offen offset:3072 nt
    s_add_u32 s56, s56, 32768
    v_dot2_f32_bf16 v23, v92, v6, 0
    v_dot2_f32_bf16 v23, v93, v7, v23
    v_dot2_f32_bf16 v23, v94, v8, v23
    v_dot2_f32_bf16 v23, v95, v9, v23
    v_add_f32_dpp v20, v20, v20 row_ror:8 row_mask:0xf bank_mask:0x3
    v_add_f32_dpp v21, v21, v21 row_ror:8 row_mask:0xf bank_mask:0x3
    s_nop 0
    v_add_f32_dpp v20, v22, v22 row_ror:8 row_mask:0xf bank_mask:0xc
    v_add_f32_dpp v21, v23, v23 row_ror:8 row_mask:0xf bank_mask:0xc
    s_nop 0
    v_add_f32_dpp v144, v20, v20 row_shl:4 row_mask:0xf bank_mask:0x5
    s_nop 1
    v_add_f32_dpp v144, v21, v21 row_shr:4 row_mask:0xf bank_mask:0xa
    s_nop 1
    v_add_f32_dpp v144, v144, v144 quad_perm:[1,0,3,2] row_mask:0xf bank_mask:0xf
    s_nop 1
    v_add_f32_dpp v144, v144, v144 quad_perm:[2,3,0,1] row_mask:0xf bank_mask:0xf
    v_cvt_pk_bf16_f32 v144, v144, v144
    v_lshlrev_b32 v144, 16, v144
    v_mul_f32 v144, s59, v144
    v_cvt_pk_bf16_f32 v144, v144, v144
    v_lshlrev_b32 v144, 16, v144
    s_waitcnt vmcnt(7)
    s_bitcmp1_b32 s52, 12
    s_cbranch_scc0 L_w12
    s_waitcnt vmcnt(5)
    s_bitcmp1_b32 s53, 12
    s_cbranch_scc0 L_w12
    s_waitcnt vmcnt(4)
L_w12:
    buffer_load_dwordx4 v[128:131], v1, s[24:27], s56 offen offset:0 nt
    s_add_u32 s57, s57, 1
    v_mov_b32 v170, s57
    buffer_store_dword v170, v168, s[8:11], 0 offen
    v_dot2_f32_bf16 v20, v96, v6, 0
    v_dot2_f32_bf16 v20, v97, v7, v20
    v_dot2_f32_bf16 v20, v98, v8, v20
    v_dot2_f32_bf16 v20, v99, v9, v20
    s_waitcnt vmcnt(7)
    s_bitcmp1_b32 s52, 13
    s_cbranch_scc0 L_w13
    s_waitcnt vmcnt(6)
    s_bitcmp1_b32 s53, 13
    s_cbranch_scc0 L_w13
    s_waitcnt vmcnt(4)
L_w13:
    buffer_load_dwordx4 v[132:135], v1, s[24:27], s56 offen offset:1024 nt
    v_dot2_f32_bf16 v21, v100, v6, 0
    v_dot2_f32_bf16 v21, v101, v7, v21
    v_dot2_f32_bf16 v21, v102, v8, v21
    v_dot2_f32_bf16 v21, v103, v9, v21
    s_waitcnt vmcnt(7)
    s_bitcmp1_b32 s52, 14
    s_cbranch_scc0 L_w14
    s_waitcnt vmcnt(5)
    s_bitcmp1_b32 s53, 14
    s_cbranch_scc0 L_w14
    s_waitcnt vmcnt(4)
L_w14:
    buffer_load_dwordx4 v[136:139], v1, s[24:27], s56 offen offset:2048 nt
    v_dot2_f32_bf16 v22, v104, v6, 0
    v_dot2_f32_bf16 v22, v105, v7, v22
    v_dot2_f32_bf16 v22, v106, v8, v22
    v_dot2_f32_bf16 v22, v107, v9, v22
    s_waitcnt vmcnt(7)
    s_bitcmp1_b32 s52, 15
    s_cbranch_scc0 L_w15
    s_waitcnt vmcnt(5)
    s_bitcmp1_b32 s53, 15
    s_cbranch_scc0 L_w15
    s_waitcnt vmcnt(4)
L_w15:
    buffer_load_dwordx4 v[140:143], v1, s[24:27], s56 offen offset:3072 nt
    s_add_u32 s56, s56, 32768
    s_cmp_ge_u32 s56, 0x100000
    s_cselect_b32 s7, 1032192, 0
    s_sub_u32 s56, s56, s7
    v_dot2_f32_bf16 v23, v108, v6, 0
    v_dot2_f32_bf16 v23, v109, v7, v23
    v_dot2_f32_bf16 v23, v110, v8, v23
    v_dot2_f32_bf16 v23, v111, v9, v23
    v_add_f32_dpp v20, v20, v20 row_ror:8 row_mask:0xf bank_mask:0x3
    v_add_f32_dpp v21, v21, v21 row_ror:8 row_mask:0xf bank_mask:0x3
    s_nop 0
    v_add_f32_dpp v20, v22, v22 row_ror:8 row_mask:0xf bank_mask:0xc
    v_add_f32_dpp v21, v23, v23 row_ror:8 row_mask:0xf bank_mask:0xc
    s_nop 0
    v_add_f32_dpp v145, v20, v20 row_shl:4 row_mask:0xf bank_mask:0x5
    s_nop 1
    v_add_f32_dpp v145, v21, v21 row_shr:4 row_mask:0xf bank_mask:0xa
    s_nop 1
    v_add_f32_dpp v145, v145, v145 quad_perm:[1,0,3,2] row_mask:0xf bank_mask:0xf
    s_nop 1
    v_add_f32_dpp v145, v145, v145 quad_perm:[2,3,0,1] row_mask:0xf bank_mask:0xf
    v_cvt_pk_bf16_f32 v145, v145, v145
    v_lshlrev_b32 v145, 16, v145
    v_mul_f32 v145, s59, v145
    v_cvt_pk_bf16_f32 v145, v145, v145
    v_lshlrev_b32 v145, 16, v145
    s_waitcnt vmcnt(7)
    s_bitcmp1_b32 s52, 16
    s_cbranch_scc0 L_w16
    s_waitcnt vmcnt(5)
    s_bitcmp1_b32 s53, 16
    s_cbranch_scc0 L_w16
    s_waitcnt vmcnt(4)
L_w16:
    buffer_load_dwordx4 v[80:83], v1, s[28:31], s55 offen offset:0 nt
    s_add_u32 s57, s57, 1
    v_mov_b32 v170, s57
    buffer_store_dword v170, v168, s[8:11], 0 offen
    v_dot2_f32_bf16 v20, v112, v6, 0
    v_dot2_f32_bf16 v20, v113, v7, v20
    v_dot2_f32_bf16 v20, v114, v8, v20
    v_dot2_f32_bf16 v20, v115, v9, v20
    s_waitcnt vmcnt(7)
    s_bitcmp1_b32 s52, 17
    s_cbranch_scc0 L_w17
    s_waitcnt vmcnt(6)
    s_bitcmp1_b32 s53, 17
    s_cbranch_scc0 L_w17
    s_waitcnt vmcnt(4)
L_w17:
    buffer_load_dwordx4 v[84:87], v1, s[28:31], s55 offen offset:1024 nt
    v_dot2_f32_bf16 v21, v116, v6, 0
    v_dot2_f32_bf16 v21, v117, v7, v21
    v_dot2_f32_bf16 v21, v118, v8, v21
    v_dot2_f32_bf16 v21, v119, v9, v21
    s_waitcnt vmcnt(7)
    s_bitcmp1_b32 s52, 18
    s_cbranch_scc0 L_w18
    s_waitcnt vmcnt(5)
    s_bitcmp1_b32 s53, 18
    s_cbranch_scc0 L_w18
    s_waitcnt vmcnt(4)
L_w18:
    buffer_load_dwordx4 v[88:91], v1, s[28:31], s55 offen offset:2048 nt
    v_dot2_f32_bf16 v22, v120, v6, 0
    v_dot2_f32_bf16 v22, v121, v7, v22
    v_dot2_f32_bf16 v22, v122, v8, v22
    v_dot2_f32_bf16 v22, v123, v9, v22
    s_waitcnt vmcnt(7)
    s_bitcmp1_b32 s52, 19
    s_cbranch_scc0 L_w19
    s_waitcnt vmcnt(5)
    s_bitcmp1_b32 s53, 19
    s_cbranch_scc0 L_w19
    s_waitcnt vmcnt(4)
L_w19:
    buffer_load_dwordx4 v[92:95], v1, s[28:31], s55 offen offset:3072 nt
    s_add_u32 s55, s55, 32768
    v_dot2_f32_bf16 v23, v124, v6, 0
    v_dot2_f32_bf16 v23, v125, v7, v23
    v_dot2_f32_bf16 v23, v126, v8, v23
    v_dot2_f32_bf16 v23, v127, v9, v23
    v_add_f32_dpp v20, v20, v20 row_ror:8 row_mask:0xf bank_mask:0x3
    v_add_f32_dpp v21, v21, v21 row_ror:8 row_mask:0xf bank_mask:0x3
    s_nop 0
    v_add_f32_dpp v20, v22, v22 row_ror:8 row_mask:0xf bank_mask:0xc
    v_add_f32_dpp v21, v23, v23 row_ror:8 row_mask:0xf bank_mask:0xc
    s_nop 0
    v_add_f32_dpp v146, v20, v20 row_shl:4 row_mask:0xf bank_mask:0x5
    s_nop 1
    v_add_f32_dpp v146, v21, v21 row_shr:4 row_mask:0xf bank_mask:0xa
    s_nop 1
    v_add_f32_dpp v146, v146, v146 quad_perm:[1,0,3,2] row_mask:0xf bank_mask:0xf
    s_nop 1
    v_add_f32_dpp v146, v146, v146 quad_perm:[2,3,0,1] row_mask:0xf bank_mask:0xf
    v_cvt_pk_bf16_f32 v146, v146, v146
    v_lshlrev_b32 v146, 16, v146
    v_mul_f32 v146, s59, v146
    v_cvt_pk_bf16_f32 v146, v146, v146
    v_lshlrev_b32 v146, 16, v146
    s_waitcnt vmcnt(7)
    s_bitcmp1_b32 s52, 20
    s_cbranch_scc0 L_w20
    s_waitcnt vmcnt(5)
    s_bitcmp1_b32 s53, 20
    s_cbranch_scc0 L_w20
    s_waitcnt vmcnt(4)
L_w20:
    buffer_load_dwordx4 v[96:99], v1, s[28:31], s55 offen offset:0 nt
    s_add_u32 s57, s57, 1
    v_mov_b32 v170, s57
    buffer_store_dword v170, v168, s[8:11], 0 offen
    v_dot2_f32_bf16 v20, v128, v6, 0
    v_dot2_f32_bf16 v20, v129, v7, v20
    v_dot2_f32_bf16 v20, v130, v8, v20
    v_dot2_f32_bf16 v20, v131, v9, v20
    s_waitcnt vmcnt(7)
    s_bitcmp1_b32 s52, 21
    s_cbranch_scc0 L_w21
    s_waitcnt vmcnt(6)
    s_bitcmp1_b32 s53, 21
    s_cbranch_scc0 L_w21
    s_waitcnt vmcnt(4)
L_w21:
    buffer_load_dwordx4 v[100:103], v1, s[28:31], s55 offen offset:1024 nt
    v_dot2_f32_bf16 v21, v132, v6, 0
    v_dot2_f32_bf16 v21, v133, v7, v21
    v_dot2_f32_bf16 v21, v134, v8, v21
    v_dot2_f32_bf16 v21, v135, v9, v21
    s_waitcnt vmcnt(7)
    s_bitcmp1_b32 s52, 22
    s_cbranch_scc0 L_w22
    s_waitcnt vmcnt(5)
    s_bitcmp1_b32 s53, 22
    s_cbranch_scc0 L_w22
    s_waitcnt vmcnt(4)
L_w22:
    buffer_load_dwordx4 v[104:107], v1, s[28:31], s55 offen offset:2048 nt
    buffer_load_dwordx2 v[172:173], v169, s[8:11], 0 offen nt
    v_dot2_f32_bf16 v22, v136, v6, 0
    v_dot2_f32_bf16 v22, v137, v7, v22
    v_dot2_f32_bf16 v22, v138, v8, v22
    v_dot2_f32_bf16 v22, v139, v9, v22
    s_waitcnt vmcnt(7)
    s_bitcmp1_b32 s52, 23
    s_cbranch_scc0 L_w23
    s_waitcnt vmcnt(6)
    s_bitcmp1_b32 s53, 23
    s_cbranch_scc0 L_w23
    s_waitcnt vmcnt(5)
L_w23:
    buffer_load_dwordx4 v[108:111], v1, s[28:31], s55 offen offset:3072 nt
    s_add_u32 s55, s55, 32768
    v_dot2_f32_bf16 v23, v140, v6, 0
    v_dot2_f32_bf16 v23, v141, v7, v23
    v_dot2_f32_bf16 v23, v142, v8, v23
    v_dot2_f32_bf16 v23, v143, v9, v23
    v_add_f32_dpp v20, v20, v20 row_ror:8 row_mask:0xf bank_mask:0x3
    v_add_f32_dpp v21, v21, v21 row_ror:8 row_mask:0xf bank_mask:0x3
    s_nop 0
    v_add_f32_dpp v20, v22, v22 row_ror:8 row_mask:0xf bank_mask:0xc
    v_add_f32_dpp v21, v23, v23 row_ror:8 row_mask:0xf bank_mask:0xc
    s_nop 0
    v_add_f32_dpp v147, v20, v20 row_shl:4 row_mask:0xf bank_mask:0x5
    s_nop 1
    v_add_f32_dpp v147, v21, v21 row_shr:4 row_mask:0xf bank_mask:0xa
    s_nop 1
    v_add_f32_dpp v147, v147, v147 quad_perm:[1,0,3,2] row_mask:0xf bank_mask:0xf
    s_nop 1
    v_add_f32_dpp v147, v147, v147 quad_perm:[2,3,0,1] row_mask:0xf bank_mask:0xf
    v_cvt_pk_bf16_f32 v147, v147, v147
    v_lshlrev_b32 v147, 16, v147
    v_mul_f32 v147, s59, v147
    v_cvt_pk_bf16_f32 v147, v147, v147
    v_lshlrev_b32 v147, 16, v147
    v_max3_f32 v24, v144, v145, v146
    v_max_f32 v24, v24, v147
    s_nop 1
    v_max_f32_dpp v24, v24, v24 row_ror:4 row_mask:0xf bank_mask:0xf
    s_nop 1
    v_max_f32_dpp v24, v24, v24 row_ror:8 row_mask:0xf bank_mask:0xf
    v_max_f32 v24, v24, v10
    v_sub_f32 v26, v10, v24
    v_sub_f32 v144, v144, v24
    v_sub_f32 v145, v145, v24
    v_sub_f32 v146, v146, v24
    v_sub_f32 v147, v147, v24
    v_mul_f32 v26, 0x3fb8aa3b, v26
    v_mul_f32 v144, 0x3fb8aa3b, v144
    v_mul_f32 v145, 0x3fb8aa3b, v145
    v_mul_f32 v146, 0x3fb8aa3b, v146
    v_mul_f32 v147, 0x3fb8aa3b, v147
    v_exp_f32 v26, v26
    v_exp_f32 v144, v144
    v_exp_f32 v145, v145
    v_exp_f32 v146, v146
    v_exp_f32 v147, v147
    v_mov_b32 v10, v24
    v_pk_mul_f32 v[12:13], v[12:13], v[26:27] op_sel_hi:[1,0]
    v_pk_mul_f32 v[14:15], v[14:15], v[26:27] op_sel_hi:[1,0]
    v_pk_mul_f32 v[16:17], v[16:17], v[26:27] op_sel_hi:[1,0]
    v_pk_mul_f32 v[18:19], v[18:19], v[26:27] op_sel_hi:[1,0]
    v_fma_f32 v11, v11, v26, v144
    v_cvt_pk_bf16_f32 v25, v144, v144
    v_and_b32 v152, v25, v4
    v_and_b32 v153, v25, v5
    v_cvt_pk_bf16_f32 v25, v145, v145
    v_add_f32 v11, v11, v145
    v_and_b32 v154, v25, v4
    v_and_b32 v155, v25, v5
    v_cvt_pk_bf16_f32 v25, v146, v146
    v_add_f32 v11, v11, v146
    v_and_b32 v156, v25, v4
    v_and_b32 v157, v25, v5
    v_cvt_pk_bf16_f32 v25, v147, v147
    v_add_f32 v11, v11, v147
    v_and_b32 v158, v25, v4
    v_and_b32 v159, v25, v5
    s_waitcnt vmcnt(7)
    s_bitcmp1_b32 s52, 24
    s_cbranch_scc0 L_w24
    s_waitcnt vmcnt(6)
    s_bitcmp1_b32 s53, 24
    s_cbranch_scc0 L_w24
    s_waitcnt vmcnt(5)
L_w24:
    buffer_load_dwordx4 v[112:115], v1, s[28:31], s55 offen offset:0 nt
    s_add_u32 s57, s57, 1
    v_mov_b32 v170, s57
    buffer_store_dword v170, v168, s[8:11], 0 offen
    v_mfma_f32_4x4x4_16b_bf16 v[12:15], v[152:153], v[80:81], v[12:15] cbsz:2 abid:0
    v_mfma_f32_4x4x4_16b_bf16 v[16:19], v[152:153], v[82:83], v[16:19] cbsz:2 abid:0
    s_waitcnt vmcnt(7)
    s_bitcmp1_b32 s52, 25
    s_cbranch_scc0 L_w25
    s_waitcnt vmcnt(7)
    s_bitcmp1_b32 s53, 25
    s_cbranch_scc0 L_w25
    s_waitcnt vmcnt(5)
L_w25:
    buffer_load_dwordx4 v[116:119], v1, s[28:31], s55 offen offset:1024 nt
    v_mfma_f32_4x4x4_16b_bf16 v[12:15], v[152:153], v[84:85], v[12:15] cbsz:2 abid:1
    v_mfma_f32_4x4x4_16b_bf16 v[16:19], v[152:153], v[86:87], v[16:19] cbsz:2 abid:1
    s_waitcnt vmcnt(7)
    s_bitcmp1_b32 s52, 26
    s_cbranch_scc0 L_w26
    s_waitcnt vmcnt(6)
    s_bitcmp1_b32 s53, 26
    s_cbranch_scc0 L_w26
    s_waitcnt vmcnt(5)
L_w26:
    buffer_load_dwordx4 v[120:123], v1, s[28:31], s55 offen offset:2048 nt
    v_mfma_f32_4x4x4_16b_bf16 v[12:15], v[152:153], v[88:89], v[12:15] cbsz:2 abid:2
    v_mfma_f32_4x4x4_16b_bf16 v[16:19], v[152:153], v[90:91], v[16:19] cbsz:2 abid:2
    s_waitcnt vmcnt(7)
    s_bitcmp1_b32 s52, 27
    s_cbranch_scc0 L_w27
    s_waitcnt vmcnt(6)
    s_bitcmp1_b32 s53, 27
    s_cbranch_scc0 L_w27
    s_waitcnt vmcnt(4)
L_w27:
    buffer_load_dwordx4 v[124:127], v1, s[28:31], s55 offen offset:3072 nt
    s_add_u32 s55, s55, 32768
    v_mfma_f32_4x4x4_16b_bf16 v[12:15], v[152:153], v[92:93], v[12:15] cbsz:2 abid:3
    v_mfma_f32_4x4x4_16b_bf16 v[16:19], v[152:153], v[94:95], v[16:19] cbsz:2 abid:3
    s_waitcnt vmcnt(7)
    s_bitcmp1_b32 s52, 28
    s_cbranch_scc0 L_w28
    s_waitcnt vmcnt(5)
    s_bitcmp1_b32 s53, 28
    s_cbranch_scc0 L_w28
    s_waitcnt vmcnt(4)
L_w28:
    buffer_load_dwordx4 v[128:131], v1, s[28:31], s55 offen offset:0 nt
    s_add_u32 s57, s57, 1
    v_mov_b32 v170, s57
    buffer_store_dword v170, v168, s[8:11], 0 offen
    v_mfma_f32_4x4x4_16b_bf16 v[12:15], v[154:155], v[96:97], v[12:15] cbsz:2 abid:0
    v_mfma_f32_4x4x4_16b_bf16 v[16:19], v[154:155], v[98:99], v[16:19] cbsz:2 abid:0
    s_waitcnt vmcnt(7)
    s_bitcmp1_b32 s52, 29
    s_cbranch_scc0 L_w29
    s_waitcnt vmcnt(6)
    s_bitcmp1_b32 s53, 29
    s_cbranch_scc0 L_w29
    s_waitcnt vmcnt(4)
L_w29:
    buffer_load_dwordx4 v[132:135], v1, s[28:31], s55 offen offset:1024 nt
    v_mfma_f32_4x4x4_16b_bf16 v[12:15], v[154:155], v[100:101], v[12:15] cbsz:2 abid:1
    v_mfma_f32_4x4x4_16b_bf16 v[16:19], v[154:155], v[102:103], v[16:19] cbsz:2 abid:1
    s_waitcnt vmcnt(7)
    s_bitcmp1_b32 s52, 30
    s_cbranch_scc0 L_w30
    s_waitcnt vmcnt(5)
    s_bitcmp1_b32 s53, 30
    s_cbranch_scc0 L_w30
    s_waitcnt vmcnt(4)
L_w30:
    buffer_load_dwordx4 v[136:139], v1, s[28:31], s55 offen offset:2048 nt
    s_sub_u32 s5, s57, 2
    v_subrev_u32 v172, s5, v172
    v_add_u32 v171, 24, v172
    v_cmp_ge_u32 vcc, 48, v171
    s_nop 1
    v_cndmask_b32 v172, 0, v172, vcc
    v_subrev_u32 v173, s5, v173
    v_add_u32 v171, 24, v173
    v_cmp_ge_u32 vcc, 48, v171
    s_nop 1
    v_cndmask_b32 v173, 0, v173, vcc
    v_add_u32 v171, v172, v173
    s_nop 1
    v_add_u32_dpp v171, v171, v171 row_ror:1 row_mask:0xf bank_mask:0xf
    s_nop 1
    v_add_u32_dpp v171, v171, v171 row_ror:2 row_mask:0xf bank_mask:0xf
    s_nop 1
    v_add_u32_dpp v171, v171, v171 row_ror:4 row_mask:0xf bank_mask:0xf
    s_nop 1
    v_add_u32_dpp v171, v171, v171 row_ror:8 row_mask:0xf bank_mask:0xf
    s_nop 0
    v_readlane_b32 s5, v171, 0
    v_readlane_b32 s4, v171, 16
    v_readlane_b32 s7, v171, 32
    v_readlane_b32 s33, v171, 48
    s_add_u32 s5, s5, s4
    s_add_u32 s7, s7, s33
    s_add_u32 s5, s5, s7
    s_abs_i32 s7, s5
    s_sub_i32 s7, s7, 16
    s_max_i32 s7, s7, 0
    s_mul_i32 s7, s7, 23
    s_lshr_b32 s7, s7, 8
    s_min_u32 s7, s7, 31
    s_bfm_b32 s7, s7, 0
    s_not_b32 s4, s7
    s_or_b32 s7, s7, 0
    s_cmp_gt_i32 s5, 0
    s_cselect_b32 s52, s4, -1
    s_cselect_b32 s53, 0, s7
    v_mfma_f32_4x4x4_16b_bf16 v[12:15], v[154:155], v[104:105], v[12:15] cbsz:2 abid:2
    v_mfma_f32_4x4x4_16b_bf16 v[16:19], v[154:155], v[106:107], v[16:19] cbsz:2 abid:2
    s_waitcnt vmcnt(7)
    s_bitcmp1_b32 s52, 31
    s_cbranch_scc0 L_w31
    s_waitcnt vmcnt(5)
    s_bitcmp1_b32 s53, 31
    s_cbranch_scc0 L_w31
    s_waitcnt vmcnt(4)
L_w31:
    buffer_load_dwordx4 v[140:143], v1, s[28:31], s55 offen offset:3072 nt
    s_add_u32 s55, s55, 32768
    s_cmp_ge_u32 s55, 0x100000
    s_cselect_b32 s7, 1032192, 0
    s_sub_u32 s55, s55, s7
    v_mfma_f32_4x4x4_16b_bf16 v[12:15], v[154:155], v[108:109], v[12:15] cbsz:2 abid:3
    v_mfma_f32_4x4x4_16b_bf16 v[16:19], v[154:155], v[110:111], v[16:19] cbsz:2 abid:3
    s_sub_u32 s63, s63, 1
    s_cmp_lg_u32 s63, 0
    s_cbranch_scc1 L_loop
    s_waitcnt vmcnt(7)
    s_bitcmp1_b32 s52, 0
    s_cbranch_scc0 L_wl0
    s_waitcnt vmcnt(7)
    s_bitcmp1_b32 s53, 0
    s_cbranch_scc0 L_wl0
    s_waitcnt vmcnt(5)
L_wl0:
    buffer_load_dwordx4 v[80:83], v1, s[24:27], s56 offen offset:0 nt
    v_mfma_f32_4x4x4_16b_bf16 v[12:15], v[156:157], v[112:113], v[12:15] cbsz:2 abid:0
    v_mfma_f32_4x4x4_16b_bf16 v[16:19], v[156:157], v[114:115], v[16:19] cbsz:2 abid:0
    s_waitcnt vmcnt(7)
    s_bitcmp1_b32 s52, 1
    s_cbranch_scc0 L_wl1
    s_waitcnt vmcnt(7)
    s_bitcmp1_b32 s53, 1
    s_cbranch_scc0 L_wl1
    s_waitcnt vmcnt(5)
L_wl1:
    buffer_load_dwordx4 v[84:87], v1, s[24:27], s56 offen offset:1024 nt
    v_mfma_f32_4x4x4_16b_bf16 v[12:15], v[156:157], v[116:117], v[12:15] cbsz:2 abid:1
    v_mfma_f32_4x4x4_16b_bf16 v[16:19], v[156:157], v[118:119], v[16:19] cbsz:2 abid:1
    s_waitcnt vmcnt(7)
    s_bitcmp1_b32 s52, 2
    s_cbranch_scc0 L_wl2
    s_waitcnt vmcnt(7)
    s_bitcmp1_b32 s53, 2
    s_cbranch_scc0 L_wl2
    s_waitcnt vmcnt(5)
L_wl2:
    buffer_load_dwordx4 v[88:91], v1, s[24:27], s56 offen offset:2048 nt
    v_mfma_f32_4x4x4_16b_bf16 v[12:15], v[156:157], v[120:121], v[12:15] cbsz:2 abid:2
    v_mfma_f32_4x4x4_16b_bf16 v[16:19], v[156:157], v[122:123], v[16:19] cbsz:2 abid:2
    s_waitcnt vmcnt(7)
    s_bitcmp1_b32 s52, 3
    s_cbranch_scc0 L_wl3
    s_waitcnt vmcnt(7)
    s_bitcmp1_b32 s53, 3
    s_cbranch_scc0 L_wl3
    s_waitcnt vmcnt(5)
L_wl3:
    buffer_load_dwordx4 v[92:95], v1, s[24:27], s56 offen offset:3072 nt
    s_add_u32 s56, s56, 32768
    v_mfma_f32_4x4x4_16b_bf16 v[12:15], v[156:157], v[124:125], v[12:15] cbsz:2 abid:3
    v_mfma_f32_4x4x4_16b_bf16 v[16:19], v[156:157], v[126:127], v[16:19] cbsz:2 abid:3
    s_waitcnt vmcnt(7)
    s_bitcmp1_b32 s52, 4
    s_cbranch_scc0 L_wl4
    s_waitcnt vmcnt(7)
    s_bitcmp1_b32 s53, 4
    s_cbranch_scc0 L_wl4
    s_waitcnt vmcnt(5)
L_wl4:
    buffer_load_dwordx4 v[96:99], v1, s[24:27], s56 offen offset:0 nt
    v_mfma_f32_4x4x4_16b_bf16 v[12:15], v[158:159], v[128:129], v[12:15] cbsz:2 abid:0
    v_mfma_f32_4x4x4_16b_bf16 v[16:19], v[158:159], v[130:131], v[16:19] cbsz:2 abid:0
    s_waitcnt vmcnt(7)
    s_bitcmp1_b32 s52, 5
    s_cbranch_scc0 L_wl5
    s_waitcnt vmcnt(7)
    s_bitcmp1_b32 s53, 5
    s_cbranch_scc0 L_wl5
    s_waitcnt vmcnt(5)
L_wl5:
    buffer_load_dwordx4 v[100:103], v1, s[24:27], s56 offen offset:1024 nt
    v_mfma_f32_4x4x4_16b_bf16 v[12:15], v[158:159], v[132:133], v[12:15] cbsz:2 abid:1
    v_mfma_f32_4x4x4_16b_bf16 v[16:19], v[158:159], v[134:135], v[16:19] cbsz:2 abid:1
    s_waitcnt vmcnt(7)
    s_bitcmp1_b32 s52, 6
    s_cbranch_scc0 L_wl6
    s_waitcnt vmcnt(7)
    s_bitcmp1_b32 s53, 6
    s_cbranch_scc0 L_wl6
    s_waitcnt vmcnt(5)
L_wl6:
    buffer_load_dwordx4 v[104:107], v1, s[24:27], s56 offen offset:2048 nt
    v_mfma_f32_4x4x4_16b_bf16 v[12:15], v[158:159], v[136:137], v[12:15] cbsz:2 abid:2
    v_mfma_f32_4x4x4_16b_bf16 v[16:19], v[158:159], v[138:139], v[16:19] cbsz:2 abid:2
    s_waitcnt vmcnt(7)
    s_bitcmp1_b32 s52, 7
    s_cbranch_scc0 L_wl7
    s_waitcnt vmcnt(7)
    s_bitcmp1_b32 s53, 7
    s_cbranch_scc0 L_wl7
    s_waitcnt vmcnt(5)
L_wl7:
    buffer_load_dwordx4 v[108:111], v1, s[24:27], s56 offen offset:3072 nt
    s_add_u32 s56, s56, 32768
    v_mfma_f32_4x4x4_16b_bf16 v[12:15], v[158:159], v[140:141], v[12:15] cbsz:2 abid:3
    v_mfma_f32_4x4x4_16b_bf16 v[16:19], v[158:159], v[142:143], v[16:19] cbsz:2 abid:3
    s_waitcnt vmcnt(7)
    s_bitcmp1_b32 s52, 8
    s_cbranch_scc0 L_wl8
    s_waitcnt vmcnt(7)
    s_bitcmp1_b32 s53, 8
    s_cbranch_scc0 L_wl8
    s_waitcnt vmcnt(5)
L_wl8:
    buffer_load_dwordx4 v[112:115], v1, s[24:27], s56 offen offset:0 nt
    v_dot2_f32_bf16 v20, v80, v6, 0
    v_dot2_f32_bf16 v20, v81, v7, v20
    v_dot2_f32_bf16 v20, v82, v8, v20
    v_dot2_f32_bf16 v20, v83, v9, v20
    s_waitcnt vmcnt(7)
    s_bitcmp1_b32 s52, 9
    s_cbranch_scc0 L_wl9
    s_waitcnt vmcnt(7)
    s_bitcmp1_b32 s53, 9
    s_cbranch_scc0 L_wl9
    s_waitcnt vmcnt(5)
L_wl9:
    buffer_load_dwordx4 v[116:119], v1, s[24:27], s56 offen offset:1024 nt
    v_dot2_f32_bf16 v21, v84, v6, 0
    v_dot2_f32_bf16 v21, v85, v7, v21
    v_dot2_f32_bf16 v21, v86, v8, v21
    v_dot2_f32_bf16 v21, v87, v9, v21
    s_waitcnt vmcnt(7)
    s_bitcmp1_b32 s52, 10
    s_cbranch_scc0 L_wl10
    s_waitcnt vmcnt(7)
    s_bitcmp1_b32 s53, 10
    s_cbranch_scc0 L_wl10
    s_waitcnt vmcnt(5)
L_wl10:
    buffer_load_dwordx4 v[120:123], v1, s[24:27], s56 offen offset:2048 nt
    v_dot2_f32_bf16 v22, v88, v6, 0
    v_dot2_f32_bf16 v22, v89, v7, v22
    v_dot2_f32_bf16 v22, v90, v8, v22
    v_dot2_f32_bf16 v22, v91, v9, v22
    s_waitcnt vmcnt(7)
    s_bitcmp1_b32 s52, 11
    s_cbranch_scc0 L_wl11
    s_waitcnt vmcnt(7)
    s_bitcmp1_b32 s53, 11
    s_cbranch_scc0 L_wl11
    s_waitcnt vmcnt(5)
L_wl11:
    buffer_load_dwordx4 v[124:127], v1, s[24:27], s56 offen offset:3072 nt
    s_add_u32 s56, s56, 32768
    v_dot2_f32_bf16 v23, v92, v6, 0
    v_dot2_f32_bf16 v23, v93, v7, v23
    v_dot2_f32_bf16 v23, v94, v8, v23
    v_dot2_f32_bf16 v23, v95, v9, v23
    v_add_f32_dpp v20, v20, v20 row_ror:8 row_mask:0xf bank_mask:0x3
    v_add_f32_dpp v21, v21, v21 row_ror:8 row_mask:0xf bank_mask:0x3
    s_nop 0
    v_add_f32_dpp v20, v22, v22 row_ror:8 row_mask:0xf bank_mask:0xc
    v_add_f32_dpp v21, v23, v23 row_ror:8 row_mask:0xf bank_mask:0xc
    s_nop 0
    v_add_f32_dpp v144, v20, v20 row_shl:4 row_mask:0xf bank_mask:0x5
    s_nop 1
    v_add_f32_dpp v144, v21, v21 row_shr:4 row_mask:0xf bank_mask:0xa
    s_nop 1
    v_add_f32_dpp v144, v144, v144 quad_perm:[1,0,3,2] row_mask:0xf bank_mask:0xf
    s_nop 1
    v_add_f32_dpp v144, v144, v144 quad_perm:[2,3,0,1] row_mask:0xf bank_mask:0xf
    v_cvt_pk_bf16_f32 v144, v144, v144
    v_lshlrev_b32 v144, 16, v144
    v_mul_f32 v144, s59, v144
    v_cvt_pk_bf16_f32 v144, v144, v144
    v_lshlrev_b32 v144, 16, v144
    s_waitcnt vmcnt(7)
    s_bitcmp1_b32 s52, 12
    s_cbranch_scc0 L_wl12
    s_waitcnt vmcnt(7)
    s_bitcmp1_b32 s53, 12
    s_cbranch_scc0 L_wl12
    s_waitcnt vmcnt(5)
L_wl12:
    buffer_load_dwordx4 v[128:131], v1, s[24:27], s56 offen offset:0 nt
    v_dot2_f32_bf16 v20, v96, v6, 0
    v_dot2_f32_bf16 v20, v97, v7, v20
    v_dot2_f32_bf16 v20, v98, v8, v20
    v_dot2_f32_bf16 v20, v99, v9, v20
    s_waitcnt vmcnt(7)
    s_bitcmp1_b32 s52, 13
    s_cbranch_scc0 L_wl13
    s_waitcnt vmcnt(7)
    s_bitcmp1_b32 s53, 13
    s_cbranch_scc0 L_wl13
    s_waitcnt vmcnt(5)
L_wl13:
    buffer_load_dwordx4 v[132:135], v1, s[24:27], s56 offen offset:1024 nt
    v_dot2_f32_bf16 v21, v100, v6, 0
    v_dot2_f32_bf16 v21, v101, v7, v21
    v_dot2_f32_bf16 v21, v102, v8, v21
    v_dot2_f32_bf16 v21, v103, v9, v21
    s_waitcnt vmcnt(7)
    s_bitcmp1_b32 s52, 14
    s_cbranch_scc0 L_wl14
    s_waitcnt vmcnt(7)
    s_bitcmp1_b32 s53, 14
    s_cbranch_scc0 L_wl14
    s_waitcnt vmcnt(5)
L_wl14:
    buffer_load_dwordx4 v[136:139], v1, s[24:27], s56 offen offset:2048 nt
    v_dot2_f32_bf16 v22, v104, v6, 0
    v_dot2_f32_bf16 v22, v105, v7, v22
    v_dot2_f32_bf16 v22, v106, v8, v22
    v_dot2_f32_bf16 v22, v107, v9, v22
    s_waitcnt vmcnt(7)
    s_bitcmp1_b32 s52, 15
    s_cbranch_scc0 L_wl15
    s_waitcnt vmcnt(7)
    s_bitcmp1_b32 s53, 15
    s_cbranch_scc0 L_wl15
    s_waitcnt vmcnt(5)
L_wl15:
    buffer_load_dwordx4 v[140:143], v1, s[24:27], s56 offen offset:3072 nt
    s_add_u32 s56, s56, 32768
    s_cmp_ge_u32 s56, 0x100000
    s_cselect_b32 s7, 1032192, 0
    s_sub_u32 s56, s56, s7
    v_dot2_f32_bf16 v23, v108, v6, 0
    v_dot2_f32_bf16 v23, v109, v7, v23
    v_dot2_f32_bf16 v23, v110, v8, v23
    v_dot2_f32_bf16 v23, v111, v9, v23
    v_add_f32_dpp v20, v20, v20 row_ror:8 row_mask:0xf bank_mask:0x3
    v_add_f32_dpp v21, v21, v21 row_ror:8 row_mask:0xf bank_mask:0x3
    s_nop 0
    v_add_f32_dpp v20, v22, v22 row_ror:8 row_mask:0xf bank_mask:0xc
    v_add_f32_dpp v21, v23, v23 row_ror:8 row_mask:0xf bank_mask:0xc
    s_nop 0
    v_add_f32_dpp v145, v20, v20 row_shl:4 row_mask:0xf bank_mask:0x5
    s_nop 1
    v_add_f32_dpp v145, v21, v21 row_shr:4 row_mask:0xf bank_mask:0xa
    s_nop 1
    v_add_f32_dpp v145, v145, v145 quad_perm:[1,0,3,2] row_mask:0xf bank_mask:0xf
    s_nop 1
    v_add_f32_dpp v145, v145, v145 quad_perm:[2,3,0,1] row_mask:0xf bank_mask:0xf
    v_cvt_pk_bf16_f32 v145, v145, v145
    v_lshlrev_b32 v145, 16, v145
    v_mul_f32 v145, s59, v145
    v_cvt_pk_bf16_f32 v145, v145, v145
    v_lshlrev_b32 v145, 16, v145
    s_waitcnt vmcnt(7)
    s_bitcmp1_b32 s52, 16
    s_cbranch_scc0 L_wl16
    s_waitcnt vmcnt(7)
    s_bitcmp1_b32 s53, 16
    s_cbranch_scc0 L_wl16
    s_waitcnt vmcnt(5)
L_wl16:
    buffer_load_dwordx4 v[80:83], v1, s[28:31], s55 offen offset:0 nt
    v_dot2_f32_bf16 v20, v112, v6, 0
    v_dot2_f32_bf16 v20, v113, v7, v20
    v_dot2_f32_bf16 v20, v114, v8, v20
    v_dot2_f32_bf16 v20, v115, v9, v20
    s_waitcnt vmcnt(7)
    s_bitcmp1_b32 s52, 17
    s_cbranch_scc0 L_wl17
    s_waitcnt vmcnt(7)
    s_bitcmp1_b32 s53, 17
    s_cbranch_scc0 L_wl17
    s_waitcnt vmcnt(5)
L_wl17:
    buffer_load_dwordx4 v[84:87], v1, s[28:31], s55 offen offset:1024 nt
    v_dot2_f32_bf16 v21, v116, v6, 0
    v_dot2_f32_bf16 v21, v117, v7, v21
    v_dot2_f32_bf16 v21, v118, v8, v21
    v_dot2_f32_bf16 v21, v119, v9, v21
    s_waitcnt vmcnt(7)
    s_bitcmp1_b32 s52, 18
    s_cbranch_scc0 L_wl18
    s_waitcnt vmcnt(7)
    s_bitcmp1_b32 s53, 18
    s_cbranch_scc0 L_wl18
    s_waitcnt vmcnt(5)
L_wl18:
    buffer_load_dwordx4 v[88:91], v1, s[28:31], s55 offen offset:2048 nt
    v_dot2_f32_bf16 v22, v120, v6, 0
    v_dot2_f32_bf16 v22, v121, v7, v22
    v_dot2_f32_bf16 v22, v122, v8, v22
    v_dot2_f32_bf16 v22, v123, v9, v22
    s_waitcnt vmcnt(7)
    s_bitcmp1_b32 s52, 19
    s_cbranch_scc0 L_wl19
    s_waitcnt vmcnt(7)
    s_bitcmp1_b32 s53, 19
    s_cbranch_scc0 L_wl19
    s_waitcnt vmcnt(5)
L_wl19:
    buffer_load_dwordx4 v[92:95], v1, s[28:31], s55 offen offset:3072 nt
    s_add_u32 s55, s55, 32768
    v_dot2_f32_bf16 v23, v124, v6, 0
    v_dot2_f32_bf16 v23, v125, v7, v23
    v_dot2_f32_bf16 v23, v126, v8, v23
    v_dot2_f32_bf16 v23, v127, v9, v23
    v_add_f32_dpp v20, v20, v20 row_ror:8 row_mask:0xf bank_mask:0x3
    v_add_f32_dpp v21, v21, v21 row_ror:8 row_mask:0xf bank_mask:0x3
    s_nop 0
    v_add_f32_dpp v20, v22, v22 row_ror:8 row_mask:0xf bank_mask:0xc
    v_add_f32_dpp v21, v23, v23 row_ror:8 row_mask:0xf bank_mask:0xc
    s_nop 0
    v_add_f32_dpp v146, v20, v20 row_shl:4 row_mask:0xf bank_mask:0x5
    s_nop 1
    v_add_f32_dpp v146, v21, v21 row_shr:4 row_mask:0xf bank_mask:0xa
    s_nop 1
    v_add_f32_dpp v146, v146, v146 quad_perm:[1,0,3,2] row_mask:0xf bank_mask:0xf
    s_nop 1
    v_add_f32_dpp v146, v146, v146 quad_perm:[2,3,0,1] row_mask:0xf bank_mask:0xf
    v_cvt_pk_bf16_f32 v146, v146, v146
    v_lshlrev_b32 v146, 16, v146
    v_mul_f32 v146, s59, v146
    v_cvt_pk_bf16_f32 v146, v146, v146
    v_lshlrev_b32 v146, 16, v146
    s_waitcnt vmcnt(7)
    s_bitcmp1_b32 s52, 20
    s_cbranch_scc0 L_wl20
    s_waitcnt vmcnt(7)
    s_bitcmp1_b32 s53, 20
    s_cbranch_scc0 L_wl20
    s_waitcnt vmcnt(5)
L_wl20:
    buffer_load_dwordx4 v[96:99], v1, s[28:31], s55 offen offset:0 nt
    v_dot2_f32_bf16 v20, v128, v6, 0
    v_dot2_f32_bf16 v20, v129, v7, v20
    v_dot2_f32_bf16 v20, v130, v8, v20
    v_dot2_f32_bf16 v20, v131, v9, v20
    s_waitcnt vmcnt(7)
    s_bitcmp1_b32 s52, 21
    s_cbranch_scc0 L_wl21
    s_waitcnt vmcnt(7)
    s_bitcmp1_b32 s53, 21
    s_cbranch_scc0 L_wl21
    s_waitcnt vmcnt(5)
L_wl21:
    buffer_load_dwordx4 v[100:103], v1, s[28:31], s55 offen offset:1024 nt
    v_dot2_f32_bf16 v21, v132, v6, 0
    v_dot2_f32_bf16 v21, v133, v7, v21
    v_dot2_f32_bf16 v21, v134, v8, v21
    v_dot2_f32_bf16 v21, v135, v9, v21
    s_waitcnt vmcnt(7)
    s_bitcmp1_b32 s52, 22
    s_cbranch_scc0 L_wl22
    s_waitcnt vmcnt(7)
    s_bitcmp1_b32 s53, 22
    s_cbranch_scc0 L_wl22
    s_waitcnt vmcnt(5)
L_wl22:
    buffer_load_dwordx4 v[104:107], v1, s[28:31], s55 offen offset:2048 nt
    v_dot2_f32_bf16 v22, v136, v6, 0
    v_dot2_f32_bf16 v22, v137, v7, v22
    v_dot2_f32_bf16 v22, v138, v8, v22
    v_dot2_f32_bf16 v22, v139, v9, v22
    s_waitcnt vmcnt(7)
    s_bitcmp1_b32 s52, 23
    s_cbranch_scc0 L_wl23
    s_waitcnt vmcnt(7)
    s_bitcmp1_b32 s53, 23
    s_cbranch_scc0 L_wl23
    s_waitcnt vmcnt(5)
L_wl23:
    buffer_load_dwordx4 v[108:111], v1, s[28:31], s55 offen offset:3072 nt
    s_add_u32 s55, s55, 32768
    v_dot2_f32_bf16 v23, v140, v6, 0
    v_dot2_f32_bf16 v23, v141, v7, v23
    v_dot2_f32_bf16 v23, v142, v8, v23
    v_dot2_f32_bf16 v23, v143, v9, v23
    v_add_f32_dpp v20, v20, v20 row_ror:8 row_mask:0xf bank_mask:0x3
    v_add_f32_dpp v21, v21, v21 row_ror:8 row_mask:0xf bank_mask:0x3
    s_nop 0
    v_add_f32_dpp v20, v22, v22 row_ror:8 row_mask:0xf bank_mask:0xc
    v_add_f32_dpp v21, v23, v23 row_ror:8 row_mask:0xf bank_mask:0xc
    s_nop 0
    v_add_f32_dpp v147, v20, v20 row_shl:4 row_mask:0xf bank_mask:0x5
    s_nop 1
    v_add_f32_dpp v147, v21, v21 row_shr:4 row_mask:0xf bank_mask:0xa
    s_nop 1
    v_add_f32_dpp v147, v147, v147 quad_perm:[1,0,3,2] row_mask:0xf bank_mask:0xf
    s_nop 1
    v_add_f32_dpp v147, v147, v147 quad_perm:[2,3,0,1] row_mask:0xf bank_mask:0xf
    v_cvt_pk_bf16_f32 v147, v147, v147
    v_lshlrev_b32 v147, 16, v147
    v_mul_f32 v147, s59, v147
    v_cvt_pk_bf16_f32 v147, v147, v147
    v_lshlrev_b32 v147, 16, v147
    v_max3_f32 v24, v144, v145, v146
    v_max_f32 v24, v24, v147
    s_nop 1
    v_max_f32_dpp v24, v24, v24 row_ror:4 row_mask:0xf bank_mask:0xf
    s_nop 1
    v_max_f32_dpp v24, v24, v24 row_ror:8 row_mask:0xf bank_mask:0xf
    v_max_f32 v24, v24, v10
    v_mov_b32 v25, v24
    s_nop 1
    v_permlane32_swap_b32 v24, v25
    v_max_f32 v24, v24, v25
    v_mov_b32 v25, v24
    s_nop 1
    v_permlane16_swap_b32 v24, v25
    v_max_f32 v24, v24, v25
    v_sub_f32 v26, v10, v24
    v_sub_f32 v144, v144, v24
    v_sub_f32 v145, v145, v24
    v_sub_f32 v146, v146, v24
    v_sub_f32 v147, v147, v24
    v_mul_f32 v26, 0x3fb8aa3b, v26
    v_mul_f32 v144, 0x3fb8aa3b, v144
    v_mul_f32 v145, 0x3fb8aa3b, v145
    v_mul_f32 v146, 0x3fb8aa3b, v146
    v_mul_f32 v147, 0x3fb8aa3b, v147
    v_exp_f32 v26, v26
    v_exp_f32 v144, v144
    v_exp_f32 v145, v145
    v_exp_f32 v146, v146
    v_exp_f32 v147, v147
    v_mov_b32 v10, v24
    v_pk_mul_f32 v[12:13], v[12:13], v[26:27] op_sel_hi:[1,0]
    v_pk_mul_f32 v[14:15], v[14:15], v[26:27] op_sel_hi:[1,0]
    v_pk_mul_f32 v[16:17], v[16:17], v[26:27] op_sel_hi:[1,0]
    v_pk_mul_f32 v[18:19], v[18:19], v[26:27] op_sel_hi:[1,0]
    v_fma_f32 v11, v11, v26, v144
    v_cvt_pk_bf16_f32 v25, v144, v144
    v_and_b32 v152, v25, v4
    v_and_b32 v153, v25, v5
    v_cvt_pk_bf16_f32 v25, v145, v145
    v_add_f32 v11, v11, v145
    v_and_b32 v154, v25, v4
    v_and_b32 v155, v25, v5
    v_cvt_pk_bf16_f32 v25, v146, v146
    v_add_f32 v11, v11, v146
    v_and_b32 v156, v25, v4
    v_and_b32 v157, v25, v5
    v_cvt_pk_bf16_f32 v25, v147, v147
    v_add_f32 v11, v11, v147
    v_and_b32 v158, v25, v4
    v_and_b32 v159, v25, v5
    v_add_f32_dpp v11, v11, v11 row_ror:4 row_mask:0xf bank_mask:0xf
    s_nop 1
    v_add_f32_dpp v11, v11, v11 row_ror:8 row_mask:0xf bank_mask:0xf
    v_mov_b32 v25, v11
    s_nop 1
    v_permlane32_swap_b32 v11, v25
    v_add_f32 v11, v11, v25
    v_mov_b32 v25, v11
    s_nop 1
    v_permlane16_swap_b32 v11, v25
    v_add_f32 v11, v11, v25
    s_lshl_b32 s7, s6, 3
    v_mov_b32 v24, s7
    s_mov_b64 exec, 1
    ds_write_b64 v24, v[10:11] offset:2048
    s_mov_b64 exec, -1
    s_waitcnt vmcnt(7)
    s_bitcmp1_b32 s52, 24
    s_cbranch_scc0 L_wl24
    s_waitcnt vmcnt(7)
    s_bitcmp1_b32 s53, 24
    s_cbranch_scc0 L_wl24
    s_waitcnt vmcnt(5)
L_wl24:
    buffer_load_dwordx4 v[112:115], v1, s[28:31], s55 offen offset:0 nt
    v_mfma_f32_4x4x4_16b_bf16 v[12:15], v[152:153], v[80:81], v[12:15] cbsz:2 abid:0
    v_mfma_f32_4x4x4_16b_bf16 v[16:19], v[152:153], v[82:83], v[16:19] cbsz:2 abid:0
    s_waitcnt vmcnt(7)
    s_bitcmp1_b32 s52, 25
    s_cbranch_scc0 L_wl25
    s_waitcnt vmcnt(7)
    s_bitcmp1_b32 s53, 25
    s_cbranch_scc0 L_wl25
    s_waitcnt vmcnt(5)
L_wl25:
    buffer_load_dwordx4 v[116:119], v1, s[28:31], s55 offen offset:1024 nt
    v_mfma_f32_4x4x4_16b_bf16 v[12:15], v[152:153], v[84:85], v[12:15] cbsz:2 abid:1
    v_mfma_f32_4x4x4_16b_bf16 v[16:19], v[152:153], v[86:87], v[16:19] cbsz:2 abid:1
    s_waitcnt vmcnt(7)
    s_bitcmp1_b32 s52, 26
    s_cbranch_scc0 L_wl26
    s_waitcnt vmcnt(7)
    s_bitcmp1_b32 s53, 26
    s_cbranch_scc0 L_wl26
    s_waitcnt vmcnt(5)
L_wl26:
    buffer_load_dwordx4 v[120:123], v1, s[28:31], s55 offen offset:2048 nt
    v_mfma_f32_4x4x4_16b_bf16 v[12:15], v[152:153], v[88:89], v[12:15] cbsz:2 abid:2
    v_mfma_f32_4x4x4_16b_bf16 v[16:19], v[152:153], v[90:91], v[16:19] cbsz:2 abid:2
    s_waitcnt vmcnt(7)
    s_bitcmp1_b32 s52, 27
    s_cbranch_scc0 L_wl27
    s_waitcnt vmcnt(7)
    s_bitcmp1_b32 s53, 27
    s_cbranch_scc0 L_wl27
    s_waitcnt vmcnt(5)
L_wl27:
    buffer_load_dwordx4 v[124:127], v1, s[28:31], s55 offen offset:3072 nt
    s_add_u32 s55, s55, 32768
    v_mfma_f32_4x4x4_16b_bf16 v[12:15], v[152:153], v[92:93], v[12:15] cbsz:2 abid:3
    v_mfma_f32_4x4x4_16b_bf16 v[16:19], v[152:153], v[94:95], v[16:19] cbsz:2 abid:3
    s_waitcnt vmcnt(7)
    s_bitcmp1_b32 s52, 28
    s_cbranch_scc0 L_wl28
    s_waitcnt vmcnt(7)
    s_bitcmp1_b32 s53, 28
    s_cbranch_scc0 L_wl28
    s_waitcnt vmcnt(5)
L_wl28:
    buffer_load_dwordx4 v[128:131], v1, s[28:31], s55 offen offset:0 nt
    v_mfma_f32_4x4x4_16b_bf16 v[12:15], v[154:155], v[96:97], v[12:15] cbsz:2 abid:0
    v_mfma_f32_4x4x4_16b_bf16 v[16:19], v[154:155], v[98:99], v[16:19] cbsz:2 abid:0
    s_waitcnt vmcnt(7)
    s_bitcmp1_b32 s52, 29
    s_cbranch_scc0 L_wl29
    s_waitcnt vmcnt(7)
    s_bitcmp1_b32 s53, 29
    s_cbranch_scc0 L_wl29
    s_waitcnt vmcnt(5)
L_wl29:
    buffer_load_dwordx4 v[132:135], v1, s[28:31], s55 offen offset:1024 nt
    v_mfma_f32_4x4x4_16b_bf16 v[12:15], v[154:155], v[100:101], v[12:15] cbsz:2 abid:1
    v_mfma_f32_4x4x4_16b_bf16 v[16:19], v[154:155], v[102:103], v[16:19] cbsz:2 abid:1
    s_waitcnt vmcnt(7)
    s_bitcmp1_b32 s52, 30
    s_cbranch_scc0 L_wl30
    s_waitcnt vmcnt(7)
    s_bitcmp1_b32 s53, 30
    s_cbranch_scc0 L_wl30
    s_waitcnt vmcnt(5)
L_wl30:
    buffer_load_dwordx4 v[136:139], v1, s[28:31], s55 offen offset:2048 nt
    v_mfma_f32_4x4x4_16b_bf16 v[12:15], v[154:155], v[104:105], v[12:15] cbsz:2 abid:2
    v_mfma_f32_4x4x4_16b_bf16 v[16:19], v[154:155], v[106:107], v[16:19] cbsz:2 abid:2
    s_waitcnt vmcnt(7)
    s_bitcmp1_b32 s52, 31
    s_cbranch_scc0 L_wl31
    s_waitcnt vmcnt(7)
    s_bitcmp1_b32 s53, 31
    s_cbranch_scc0 L_wl31
    s_waitcnt vmcnt(5)
L_wl31:
    buffer_load_dwordx4 v[140:143], v1, s[28:31], s55 offen offset:3072 nt
    s_add_u32 s55, s55, 32768
    s_cmp_ge_u32 s55, 0x100000
    s_cselect_b32 s7, 1032192, 0
    s_sub_u32 s55, s55, s7
    v_mfma_f32_4x4x4_16b_bf16 v[12:15], v[154:155], v[108:109], v[12:15] cbsz:2 abid:3
    v_mfma_f32_4x4x4_16b_bf16 v[16:19], v[154:155], v[110:111], v[16:19] cbsz:2 abid:3
    s_waitcnt lgkmcnt(0)
    s_barrier
    ds_read_b128 v[44:47], v31 offset:2048
    ds_read_b128 v[48:51], v31 offset:2064
    s_waitcnt vmcnt(7)
    buffer_load_dwordx4 a[120:123], v3, s[36:39], s54 offen offset:0
    buffer_load_dwordx4 a[124:127], v3, s[36:39], s54 offen offset:256
    buffer_load_dwordx4 a[128:131], v3, s[36:39], s54 offen offset:512
    v_mfma_f32_4x4x4_16b_bf16 v[12:15], v[156:157], v[112:113], v[12:15] cbsz:2 abid:0
    v_mfma_f32_4x4x4_16b_bf16 v[16:19], v[156:157], v[114:115], v[16:19] cbsz:2 abid:0
    s_waitcnt lgkmcnt(0)
    v_max3_f32 v24, v44, v46, v48
    v_max_f32 v24, v24, v50
    v_sub_f32 v44, v44, v24
    v_sub_f32 v46, v46, v24
    v_sub_f32 v48, v48, v24
    v_sub_f32 v50, v50, v24
    v_sub_f32 v28, v10, v24
    v_mul_f32 v44, 0x3fb8aa3b, v44
    v_mul_f32 v46, 0x3fb8aa3b, v46
    v_mul_f32 v48, 0x3fb8aa3b, v48
    v_mul_f32 v50, 0x3fb8aa3b, v50
    v_mul_f32 v28, 0x3fb8aa3b, v28
    v_exp_f32 v44, v44
    v_exp_f32 v46, v46
    v_exp_f32 v48, v48
    v_exp_f32 v50, v50
    v_exp_f32 v28, v28
    v_mul_f32 v24, v44, v45
    v_fmac_f32 v24, v46, v47
    v_fmac_f32 v24, v48, v49
    v_fmac_f32 v24, v50, v51
    v_rcp_f32 v24, v24
    s_nop 0
    v_mul_f32 v28, v28, v24
    s_waitcnt vmcnt(9)
    buffer_load_dwordx4 a[132:135], v3, s[36:39], s54 offen offset:768
    v_mfma_f32_4x4x4_16b_bf16 v[12:15], v[156:157], v[116:117], v[12:15] cbsz:2 abid:1
    v_mfma_f32_4x4x4_16b_bf16 v[16:19], v[156:157], v[118:119], v[16:19] cbsz:2 abid:1
    s_waitcnt vmcnt(9)
    buffer_load_dwordx4 a[136:139], v3, s[36:39], s54 offen offset:1024
    s_add_u32 s54, s54, 5120
    v_mfma_f32_4x4x4_16b_bf16 v[12:15], v[156:157], v[120:121], v[12:15] cbsz:2 abid:2
    v_mfma_f32_4x4x4_16b_bf16 v[16:19], v[156:157], v[122:123], v[16:19] cbsz:2 abid:2
    s_waitcnt vmcnt(9)
    buffer_load_dwordx4 a[140:143], v3, s[36:39], s54 offen offset:0
    v_mfma_f32_4x4x4_16b_bf16 v[12:15], v[156:157], v[124:125], v[12:15] cbsz:2 abid:3
    v_mfma_f32_4x4x4_16b_bf16 v[16:19], v[156:157], v[126:127], v[16:19] cbsz:2 abid:3
    s_waitcnt vmcnt(9)
    buffer_load_dwordx4 a[144:147], v3, s[36:39], s54 offen offset:256
    v_mfma_f32_4x4x4_16b_bf16 v[12:15], v[158:159], v[128:129], v[12:15] cbsz:2 abid:0
    v_mfma_f32_4x4x4_16b_bf16 v[16:19], v[158:159], v[130:131], v[16:19] cbsz:2 abid:0
    s_waitcnt vmcnt(9)
    buffer_load_dwordx4 a[148:151], v3, s[36:39], s54 offen offset:512
    v_mfma_f32_4x4x4_16b_bf16 v[12:15], v[158:159], v[132:133], v[12:15] cbsz:2 abid:1
    v_mfma_f32_4x4x4_16b_bf16 v[16:19], v[158:159], v[134:135], v[16:19] cbsz:2 abid:1
    s_waitcnt vmcnt(9)
    buffer_load_dwordx4 a[152:155], v3, s[36:39], s54 offen offset:768
    v_mfma_f32_4x4x4_16b_bf16 v[12:15], v[158:159], v[136:137], v[12:15] cbsz:2 abid:2
    v_mfma_f32_4x4x4_16b_bf16 v[16:19], v[158:159], v[138:139], v[16:19] cbsz:2 abid:2
    s_waitcnt vmcnt(9)
    buffer_load_dwordx4 a[156:159], v3, s[36:39], s54 offen offset:1024
    s_add_u32 s54, s54, 5120
    v_mfma_f32_4x4x4_16b_bf16 v[12:15], v[158:159], v[140:141], v[12:15] cbsz:2 abid:3
    v_mfma_f32_4x4x4_16b_bf16 v[16:19], v[158:159], v[142:143], v[16:19] cbsz:2 abid:3
    s_nop 4
    v_permlane32_swap_b32 v12, v16
    v_permlane32_swap_b32 v13, v17
    v_permlane32_swap_b32 v14, v18
    v_permlane32_swap_b32 v15, v19
    v_pk_add_f32 v[12:13], v[12:13], v[16:17]
    v_pk_add_f32 v[14:15], v[14:15], v[18:19]
    s_nop 1
    v_permlane16_swap_b32 v12, v14
    v_permlane16_swap_b32 v13, v15
    v_pk_add_f32 v[12:13], v[12:13], v[14:15]
    v_pk_mul_f32 v[12:13], v[12:13], v[28:29] op_sel_hi:[1,0]
    ds_write_b64 v38, v[12:13] offset:4096
    s_waitcnt lgkmcnt(0)
    s_barrier
    ds_read2st64_b32 v[44:45], v39 offset0:0 offset1:2
    ds_read2st64_b32 v[46:47], v39 offset0:4 offset1:6
    s_waitcnt lgkmcnt(0)
    s_cmp_lg_u32 s6, 0
    s_cbranch_scc1 L_nock
    s_atomic_add s60, s[18:19], s61 glc
L_nock:
    v_pk_add_f32 v[44:45], v[44:45], v[46:47]
    v_add_f32 v44, v44, v45
    v_cvt_pk_bf16_f32 v25, v44, v44
    s_nop 1
    v_and_b32_dpp v68, v25, v32 row_newbcast:0 row_mask:0xf bank_mask:0xf
    v_and_b32_dpp v69, v25, v33 row_newbcast:0 row_mask:0xf bank_mask:0xf
    v_and_b32_dpp v70, v25, v34 row_newbcast:0 row_mask:0xf bank_mask:0xf
    v_and_b32_dpp v71, v25, v35 row_newbcast:0 row_mask:0xf bank_mask:0xf
    s_nop 1
    v_mfma_f32_16x16x32_bf16 v[48:51], v[68:71], a[0:3], 0
    v_and_b32_dpp v72, v25, v32 row_newbcast:1 row_mask:0xf bank_mask:0xf
    v_mfma_f32_16x16x32_bf16 v[52:55], v[68:71], a[4:7], 0
    v_and_b32_dpp v73, v25, v33 row_newbcast:1 row_mask:0xf bank_mask:0xf
    v_mfma_f32_16x16x32_bf16 v[56:59], v[68:71], a[8:11], 0
    v_and_b32_dpp v74, v25, v34 row_newbcast:1 row_mask:0xf bank_mask:0xf
    v_mfma_f32_16x16x32_bf16 v[60:63], v[68:71], a[12:15], 0
    v_and_b32_dpp v75, v25, v35 row_newbcast:1 row_mask:0xf bank_mask:0xf
    v_mfma_f32_16x16x32_bf16 v[64:67], v[68:71], a[16:19], 0
    s_nop 0
    v_mfma_f32_16x16x32_bf16 v[48:51], v[72:75], a[20:23], v[48:51]
    v_and_b32_dpp v68, v25, v32 row_newbcast:2 row_mask:0xf bank_mask:0xf
    v_mfma_f32_16x16x32_bf16 v[52:55], v[72:75], a[24:27], v[52:55]
    v_and_b32_dpp v69, v25, v33 row_newbcast:2 row_mask:0xf bank_mask:0xf
    v_mfma_f32_16x16x32_bf16 v[56:59], v[72:75], a[28:31], v[56:59]
    v_and_b32_dpp v70, v25, v34 row_newbcast:2 row_mask:0xf bank_mask:0xf
    v_mfma_f32_16x16x32_bf16 v[60:63], v[72:75], a[32:35], v[60:63]
    v_and_b32_dpp v71, v25, v35 row_newbcast:2 row_mask:0xf bank_mask:0xf
    v_mfma_f32_16x16x32_bf16 v[64:67], v[72:75], a[36:39], v[64:67]
    s_nop 0
    v_mfma_f32_16x16x32_bf16 v[48:51], v[68:71], a[40:43], v[48:51]
    v_and_b32_dpp v72, v25, v32 row_newbcast:3 row_mask:0xf bank_mask:0xf
    v_mfma_f32_16x16x32_bf16 v[52:55], v[68:71], a[44:47], v[52:55]
    v_and_b32_dpp v73, v25, v33 row_newbcast:3 row_mask:0xf bank_mask:0xf
    v_mfma_f32_16x16x32_bf16 v[56:59], v[68:71], a[48:51], v[56:59]
    v_and_b32_dpp v74, v25, v34 row_newbcast:3 row_mask:0xf bank_mask:0xf
    v_mfma_f32_16x16x32_bf16 v[60:63], v[68:71], a[52:55], v[60:63]
    v_and_b32_dpp v75, v25, v35 row_newbcast:3 row_mask:0xf bank_mask:0xf
    v_mfma_f32_16x16x32_bf16 v[64:67], v[68:71], a[56:59], v[64:67]
    s_nop 0
    v_mfma_f32_16x16x32_bf16 v[48:51], v[72:75], a[60:63], v[48:51]
    v_and_b32_dpp v68, v25, v32 row_newbcast:4 row_mask:0xf bank_mask:0xf
    v_mfma_f32_16x16x32_bf16 v[52:55], v[72:75], a[64:67], v[52:55]
    v_and_b32_dpp v69, v25, v33 row_newbcast:4 row_mask:0xf bank_mask:0xf
    v_mfma_f32_16x16x32_bf16 v[56:59], v[72:75], a[68:71], v[56:59]
    v_and_b32_dpp v70, v25, v34 row_newbcast:4 row_mask:0xf bank_mask:0xf
    v_mfma_f32_16x16x32_bf16 v[60:63], v[72:75], a[72:75], v[60:63]
    v_and_b32_dpp v71, v25, v35 row_newbcast:4 row_mask:0xf bank_mask:0xf
    v_mfma_f32_16x16x32_bf16 v[64:67], v[72:75], a[76:79], v[64:67]
    s_nop 0
    v_mfma_f32_16x16x32_bf16 v[48:51], v[68:71], a[80:83], v[48:51]
    v_and_b32_dpp v72, v25, v32 row_newbcast:5 row_mask:0xf bank_mask:0xf
    v_mfma_f32_16x16x32_bf16 v[52:55], v[68:71], a[84:87], v[52:55]
    v_and_b32_dpp v73, v25, v33 row_newbcast:5 row_mask:0xf bank_mask:0xf
    v_mfma_f32_16x16x32_bf16 v[56:59], v[68:71], a[88:91], v[56:59]
    v_and_b32_dpp v74, v25, v34 row_newbcast:5 row_mask:0xf bank_mask:0xf
    v_mfma_f32_16x16x32_bf16 v[60:63], v[68:71], a[92:95], v[60:63]
    v_and_b32_dpp v75, v25, v35 row_newbcast:5 row_mask:0xf bank_mask:0xf
    v_mfma_f32_16x16x32_bf16 v[64:67], v[68:71], a[96:99], v[64:67]
    s_nop 0
    v_mfma_f32_16x16x32_bf16 v[48:51], v[72:75], a[100:103], v[48:51]
    v_and_b32_dpp v68, v25, v32 row_newbcast:6 row_mask:0xf bank_mask:0xf
    v_mfma_f32_16x16x32_bf16 v[52:55], v[72:75], a[104:107], v[52:55]
    v_and_b32_dpp v69, v25, v33 row_newbcast:6 row_mask:0xf bank_mask:0xf
    v_mfma_f32_16x16x32_bf16 v[56:59], v[72:75], a[108:111], v[56:59]
    v_and_b32_dpp v70, v25, v34 row_newbcast:6 row_mask:0xf bank_mask:0xf
    v_mfma_f32_16x16x32_bf16 v[60:63], v[72:75], a[112:115], v[60:63]
    v_and_b32_dpp v71, v25, v35 row_newbcast:6 row_mask:0xf bank_mask:0xf
    v_mfma_f32_16x16x32_bf16 v[64:67], v[72:75], a[116:119], v[64:67]
    s_waitcnt vmcnt(9)
    v_mfma_f32_16x16x32_bf16 v[48:51], v[68:71], a[120:123], v[48:51]
    v_and_b32_dpp v72, v25, v32 row_newbcast:7 row_mask:0xf bank_mask:0xf
    s_waitcnt vmcnt(8)
    v_mfma_f32_16x16x32_bf16 v[52:55], v[68:71], a[124:127], v[52:55]
    v_and_b32_dpp v73, v25, v33 row_newbcast:7 row_mask:0xf bank_mask:0xf
    s_waitcnt vmcnt(7)
    v_mfma_f32_16x16x32_bf16 v[56:59], v[68:71], a[128:131], v[56:59]
    v_and_b32_dpp v74, v25, v34 row_newbcast:7 row_mask:0xf bank_mask:0xf
    s_waitcnt vmcnt(6)
    v_mfma_f32_16x16x32_bf16 v[60:63], v[68:71], a[132:135], v[60:63]
    v_and_b32_dpp v75, v25, v35 row_newbcast:7 row_mask:0xf bank_mask:0xf
    s_waitcnt vmcnt(5)
    v_mfma_f32_16x16x32_bf16 v[64:67], v[68:71], a[136:139], v[64:67]
    s_waitcnt vmcnt(4)
    v_mfma_f32_16x16x32_bf16 v[48:51], v[72:75], a[140:143], v[48:51]
    s_waitcnt vmcnt(3)
    v_mfma_f32_16x16x32_bf16 v[52:55], v[72:75], a[144:147], v[52:55]
    s_waitcnt vmcnt(2)
    v_mfma_f32_16x16x32_bf16 v[56:59], v[72:75], a[148:151], v[56:59]
    s_waitcnt vmcnt(1)
    v_mfma_f32_16x16x32_bf16 v[60:63], v[72:75], a[152:155], v[60:63]
    s_waitcnt vmcnt(0)
    v_mfma_f32_16x16x32_bf16 v[64:67], v[72:75], a[156:159], v[64:67]
    s_mov_b64 exec, 0xffffffff
    ds_write_b128 v40, v[48:51] offset:0
    ds_write_b128 v40, v[52:55] offset:512
    s_nop 0
    ds_write_b128 v40, v[56:59] offset:1024
    s_nop 0
    ds_write_b128 v40, v[60:63] offset:1536
    s_nop 0
    ds_write_b128 v40, v[64:67] offset:2048
    s_mov_b64 exec, -1
    s_cmp_lg_u32 s6, 0
    s_cbranch_scc1 L_nofl
    s_waitcnt lgkmcnt(0)
    v_mov_b32 v30, s60
    s_mov_b64 exec, 1
    ds_write_b32 v31, v30 offset:2112
    s_mov_b64 exec, -1
L_nofl:
    s_waitcnt lgkmcnt(0)
    s_barrier
    ds_read_b32 v30, v31 offset:2112
    ds_read_b128 v[44:47], v41 offset:0
    ds_read_b128 v[48:51], v41 offset:2560
    ds_read_b128 v[52:55], v41 offset:5120
    ds_read_b128 v[56:59], v41 offset:7680
    s_waitcnt lgkmcnt(4)
    v_readfirstlane_b32 s60, v30
    s_nop 0
    s_cmp_eq_u32 s60, 31
    s_cbranch_scc1 L_red
    s_waitcnt lgkmcnt(0)
    v_pk_add_f32 v[44:45], v[44:45], v[48:49]
    v_pk_add_f32 v[46:47], v[46:47], v[50:51]
    v_pk_add_f32 v[52:53], v[52:53], v[56:57]
    v_pk_add_f32 v[54:55], v[54:55], v[58:59]
    v_pk_add_f32 v[44:45], v[44:45], v[52:53]
    v_pk_add_f32 v[46:47], v[46:47], v[54:55]
    v_min_u32 v44, -2, v44
    v_min_u32 v45, -2, v45
    v_min_u32 v46, -2, v46
    v_min_u32 v47, -2, v47
    buffer_store_dwordx4 v[44:47], v36, s[44:47], s58 offen sc1
    s_endpgm
L_red:
    buffer_load_dwordx4 v[252:255], v36, s[44:47], s95 offen sc1
    buffer_load_dwordx4 v[248:251], v36, s[44:47], s94 offen sc1
    buffer_load_dwordx4 v[244:247], v36, s[44:47], s93 offen sc1
    buffer_load_dwordx4 v[240:243], v36, s[44:47], s92 offen sc1
    buffer_load_dwordx4 v[220:223], v36, s[44:47], s87 offen sc1
    buffer_load_dwordx4 v[216:219], v36, s[44:47], s86 offen sc1
    buffer_load_dwordx4 v[212:215], v36, s[44:47], s85 offen sc1
    buffer_load_dwordx4 v[208:211], v36, s[44:47], s84 offen sc1
    buffer_load_dwordx4 v[188:191], v36, s[44:47], s79 offen sc1
    buffer_load_dwordx4 v[184:187], v36, s[44:47], s78 offen sc1
    buffer_load_dwordx4 v[180:183], v36, s[44:47], s77 offen sc1
    buffer_load_dwordx4 v[176:179], v36, s[44:47], s76 offen sc1
    buffer_load_dwordx4 v[156:159], v36, s[44:47], s71 offen sc1
    buffer_load_dwordx4 v[152:155], v36, s[44:47], s70 offen sc1
    buffer_load_dwordx4 v[148:151], v36, s[44:47], s69 offen sc1
    buffer_load_dwordx4 v[144:147], v36, s[44:47], s68 offen sc1
    buffer_load_dwordx4 v[236:239], v36, s[44:47], s91 offen sc1
    buffer_load_dwordx4 v[232:235], v36, s[44:47], s90 offen sc1
    buffer_load_dwordx4 v[228:231], v36, s[44:47], s89 offen sc1
    buffer_load_dwordx4 v[204:207], v36, s[44:47], s83 offen sc1
    buffer_load_dwordx4 v[200:203], v36, s[44:47], s82 offen sc1
    buffer_load_dwordx4 v[196:199], v36, s[44:47], s81 offen sc1
    buffer_load_dwordx4 v[172:175], v36, s[44:47], s75 offen sc1
    buffer_load_dwordx4 v[168:171], v36, s[44:47], s74 offen sc1
    buffer_load_dwordx4 v[164:167], v36, s[44:47], s73 offen sc1
    buffer_load_dwordx4 v[140:143], v36, s[44:47], s67 offen sc1
    buffer_load_dwordx4 v[136:139], v36, s[44:47], s66 offen sc1
    buffer_load_dwordx4 v[132:135], v36, s[44:47], s65 offen sc1
    buffer_load_dwordx4 v[224:227], v36, s[44:47], s88 offen sc1
    buffer_load_dwordx4 v[192:195], v36, s[44:47], s80 offen sc1
    buffer_load_dwordx4 v[160:163], v36, s[44:47], s72 offen sc1
    s_waitcnt lgkmcnt(0)
    v_pk_add_f32 v[44:45], v[44:45], v[48:49]
    v_pk_add_f32 v[46:47], v[46:47], v[50:51]
    v_pk_add_f32 v[52:53], v[52:53], v[56:57]
    v_pk_add_f32 v[54:55], v[54:55], v[58:59]
    v_pk_add_f32 v[128:129], v[44:45], v[52:53]
    v_pk_add_f32 v[130:131], v[46:47], v[54:55]
    s_waitcnt vmcnt(27)
    v_pk_add_f32 v[112:113], v[240:241], v[244:245]
    v_pk_add_f32 v[114:115], v[242:243], v[246:247]
    v_pk_add_f32 v[116:117], v[248:249], v[252:253]
    v_pk_add_f32 v[118:119], v[250:251], v[254:255]
    v_pk_add_f32 v[108:109], v[112:113], v[116:117]
    v_pk_add_f32 v[110:111], v[114:115], v[118:119]
    s_waitcnt vmcnt(23)
    v_pk_add_f32 v[112:113], v[208:209], v[212:213]
    v_pk_add_f32 v[114:115], v[210:211], v[214:215]
    v_pk_add_f32 v[116:117], v[216:217], v[220:221]
    v_pk_add_f32 v[118:119], v[218:219], v[222:223]
    v_pk_add_f32 v[100:101], v[112:113], v[116:117]
    v_pk_add_f32 v[102:103], v[114:115], v[118:119]
    s_waitcnt vmcnt(19)
    v_pk_add_f32 v[112:113], v[176:177], v[180:181]
    v_pk_add_f32 v[114:115], v[178:179], v[182:183]
    v_pk_add_f32 v[116:117], v[184:185], v[188:189]
    v_pk_add_f32 v[118:119], v[186:187], v[190:191]
    v_pk_add_f32 v[92:93], v[112:113], v[116:117]
    v_pk_add_f32 v[94:95], v[114:115], v[118:119]
    s_waitcnt vmcnt(15)
    v_pk_add_f32 v[112:113], v[144:145], v[148:149]
    v_pk_add_f32 v[114:115], v[146:147], v[150:151]
    v_pk_add_f32 v[116:117], v[152:153], v[156:157]
    v_pk_add_f32 v[118:119], v[154:155], v[158:159]
    v_pk_add_f32 v[84:85], v[112:113], v[116:117]
    v_pk_add_f32 v[86:87], v[114:115], v[118:119]
    s_waitcnt vmcnt(2)
    v_pk_add_f32 v[112:113], v[224:225], v[228:229]
    v_pk_add_f32 v[114:115], v[226:227], v[230:231]
    v_pk_add_f32 v[116:117], v[232:233], v[236:237]
    v_pk_add_f32 v[118:119], v[234:235], v[238:239]
    v_pk_add_f32 v[104:105], v[112:113], v[116:117]
    v_pk_add_f32 v[106:107], v[114:115], v[118:119]
    s_waitcnt vmcnt(1)
    v_pk_add_f32 v[112:113], v[192:193], v[196:197]
    v_pk_add_f32 v[114:115], v[194:195], v[198:199]
    v_pk_add_f32 v[116:117], v[200:201], v[204:205]
    v_pk_add_f32 v[118:119], v[202:203], v[206:207]
    v_pk_add_f32 v[96:97], v[112:113], v[116:117]
    v_pk_add_f32 v[98:99], v[114:115], v[118:119]
    s_waitcnt vmcnt(0)
    v_pk_add_f32 v[112:113], v[160:161], v[164:165]
    v_pk_add_f32 v[114:115], v[162:163], v[166:167]
    v_pk_add_f32 v[116:117], v[168:169], v[172:173]
    v_pk_add_f32 v[118:119], v[170:171], v[174:175]
    v_pk_add_f32 v[88:89], v[112:113], v[116:117]
    v_pk_add_f32 v[90:91], v[114:115], v[118:119]
    s_mov_b32 s63, 0x100000
    s_waitcnt vmcnt(0)
    v_pk_add_f32 v[112:113], v[128:129], v[132:133]
    v_pk_add_f32 v[114:115], v[130:131], v[134:135]
    v_pk_add_f32 v[116:117], v[136:137], v[140:141]
    v_pk_add_f32 v[118:119], v[138:139], v[142:143]
    v_pk_add_f32 v[80:81], v[112:113], v[116:117]
    v_pk_add_f32 v[82:83], v[114:115], v[118:119]
L_sum:
    v_pk_add_f32 v[44:45], v[80:81], v[84:85]
    v_pk_add_f32 v[46:47], v[82:83], v[86:87]
    v_pk_add_f32 v[48:49], v[88:89], v[92:93]
    v_pk_add_f32 v[50:51], v[90:91], v[94:95]
    v_pk_add_f32 v[52:53], v[96:97], v[100:101]
    v_pk_add_f32 v[54:55], v[98:99], v[102:103]
    v_pk_add_f32 v[56:57], v[104:105], v[108:109]
    v_pk_add_f32 v[58:59], v[106:107], v[110:111]
    v_pk_add_f32 v[44:45], v[44:45], v[48:49]
    v_pk_add_f32 v[46:47], v[46:47], v[50:51]
    v_pk_add_f32 v[52:53], v[52:53], v[56:57]
    v_pk_add_f32 v[54:55], v[54:55], v[58:59]
    v_pk_add_f32 v[44:45], v[44:45], v[52:53]
    v_pk_add_f32 v[46:47], v[46:47], v[54:55]
    v_cmp_u_f32 vcc, v44, v45
    v_cmp_u_f32 s[4:5], v46, v47
    s_nop 0
    s_or_b64 vcc, vcc, s[4:5]
    s_cbranch_scc0 L_done
    s_mov_b32 s62, 0
    v_cmp_u_f32 vcc, v108, v109
    v_cmp_u_f32 s[4:5], v110, v111
    s_nop 0
    s_or_b64 vcc, vcc, s[4:5]
    s_addc_u32 s62, s62, s62
    v_cmp_u_f32 vcc, v104, v105
    v_cmp_u_f32 s[4:5], v106, v107
    s_nop 0
    s_or_b64 vcc, vcc, s[4:5]
    s_addc_u32 s62, s62, s62
    v_cmp_u_f32 vcc, v100, v101
    v_cmp_u_f32 s[4:5], v102, v103
    s_nop 0
    s_or_b64 vcc, vcc, s[4:5]
    s_addc_u32 s62, s62, s62
    v_cmp_u_f32 vcc, v96, v97
    v_cmp_u_f32 s[4:5], v98, v99
    s_nop 0
    s_or_b64 vcc, vcc, s[4:5]
    s_addc_u32 s62, s62, s62
    v_cmp_u_f32 vcc, v92, v93
    v_cmp_u_f32 s[4:5], v94, v95
    s_nop 0
    s_or_b64 vcc, vcc, s[4:5]
    s_addc_u32 s62, s62, s62
    v_cmp_u_f32 vcc, v88, v89
    v_cmp_u_f32 s[4:5], v90, v91
    s_nop 0
    s_or_b64 vcc, vcc, s[4:5]
    s_addc_u32 s62, s62, s62
    v_cmp_u_f32 vcc, v84, v85
    v_cmp_u_f32 s[4:5], v86, v87
    s_nop 0
    s_or_b64 vcc, vcc, s[4:5]
    s_addc_u32 s62, s62, s62
    v_cmp_u_f32 vcc, v80, v81
    v_cmp_u_f32 s[4:5], v82, v83
    s_nop 0
    s_or_b64 vcc, vcc, s[4:5]
    s_addc_u32 s62, s62, s62
    s_sub_u32 s63, s63, 1
    s_and_b32 s7, s63, 7
    s_cbranch_scc1 L_poll
    v_max_u32 v22, v132, v133
    v_max3_u32 v22, v22, v134, v135
    v_max3_u32 v22, v22, v136, v137
    v_max3_u32 v22, v22, v138, v139
    v_max3_u32 v22, v22, v140, v141
    v_max3_u32 v22, v22, v142, v143
    v_max3_u32 v22, v22, v144, v145
    v_max3_u32 v22, v22, v146, v147
    v_max3_u32 v22, v22, v148, v149
    v_max3_u32 v22, v22, v150, v151
    v_max3_u32 v22, v22, v152, v153
    v_max3_u32 v22, v22, v154, v155
    v_max3_u32 v22, v22, v156, v157
    v_max3_u32 v22, v22, v158, v159
    v_max3_u32 v22, v22, v160, v161
    v_max3_u32 v22, v22, v162, v163
    v_max3_u32 v22, v22, v164, v165
    v_max3_u32 v22, v22, v166, v167
    v_max3_u32 v22, v22, v168, v169
    v_max3_u32 v22, v22, v170, v171
    v_max3_u32 v22, v22, v172, v173
    v_max3_u32 v22, v22, v174, v175
    v_max3_u32 v22, v22, v176, v177
    v_max3_u32 v22, v22, v178, v179
    v_max3_u32 v22, v22, v180, v181
    v_max3_u32 v22, v22, v182, v183
    v_max3_u32 v22, v22, v184, v185
    v_max3_u32 v22, v22, v186, v187
    v_max3_u32 v22, v22, v188, v189
    v_max3_u32 v22, v22, v190, v191
    v_max3_u32 v22, v22, v192, v193
    v_max3_u32 v22, v22, v194, v195
    v_max3_u32 v22, v22, v196, v197
    v_max3_u32 v22, v22, v198, v199
    v_max3_u32 v22, v22, v200, v201
    v_max3_u32 v22, v22, v202, v203
    v_max3_u32 v22, v22, v204, v205
    v_max3_u32 v22, v22, v206, v207
    v_max3_u32 v22, v22, v208, v209
    v_max3_u32 v22, v22, v210, v211
    v_max3_u32 v22, v22, v212, v213
    v_max3_u32 v22, v22, v214, v215
    v_max3_u32 v22, v22, v216, v217
    v_max3_u32 v22, v22, v218, v219
    v_max3_u32 v22, v22, v220, v221
    v_max3_u32 v22, v22, v222, v223
    v_max3_u32 v22, v22, v224, v225
    v_max3_u32 v22, v22, v226, v227
    v_max3_u32 v22, v22, v228, v229
    v_max3_u32 v22, v22, v230, v231
    v_max3_u32 v22, v22, v232, v233
    v_max3_u32 v22, v22, v234, v235
    v_max3_u32 v22, v22, v236, v237
    v_max3_u32 v22, v22, v238, v239
    v_max3_u32 v22, v22, v240, v241
    v_max3_u32 v22, v22, v242, v243
    v_max3_u32 v22, v22, v244, v245
    v_max3_u32 v22, v22, v246, v247
    v_max3_u32 v22, v22, v248, v249
    v_max3_u32 v22, v22, v250, v251
    v_max3_u32 v22, v22, v252, v253
    v_max3_u32 v22, v22, v254, v255
    v_cmp_eq_u32 vcc, -1, v22
    s_nop 0
    s_cmp_lg_u64 vcc, 0
    s_cselect_b32 s7, 1, 0x100000
    s_sub_u32 s63, s63, s7
    s_cmp_gt_i32 s63, 0
    s_cbranch_scc0 L_done
L_poll:
    s_bitcmp1_b32 s62, 0
    s_cbranch_scc0 L_np0
    buffer_load_dwordx4 v[132:135], v36, s[44:47], s65 offen sc1
    buffer_load_dwordx4 v[136:139], v36, s[44:47], s66 offen sc1
    buffer_load_dwordx4 v[140:143], v36, s[44:47], s67 offen sc1
L_np0:
    s_bitcmp1_b32 s62, 1
    s_cbranch_scc0 L_np1
    buffer_load_dwordx4 v[144:147], v36, s[44:47], s68 offen sc1
    buffer_load_dwordx4 v[148:151], v36, s[44:47], s69 offen sc1
    buffer_load_dwordx4 v[152:155], v36, s[44:47], s70 offen sc1
    buffer_load_dwordx4 v[156:159], v36, s[44:47], s71 offen sc1
L_np1:
    s_bitcmp1_b32 s62, 2
    s_cbranch_scc0 L_np2
    buffer_load_dwordx4 v[160:163], v36, s[44:47], s72 offen sc1
    buffer_load_dwordx4 v[164:167], v36, s[44:47], s73 offen sc1
    buffer_load_dwordx4 v[168:171], v36, s[44:47], s74 offen sc1
    buffer_load_dwordx4 v[172:175], v36, s[44:47], s75 offen sc1
L_np2:
    s_bitcmp1_b32 s62, 3
    s_cbranch_scc0 L_np3
    buffer_load_dwordx4 v[176:179], v36, s[44:47], s76 offen sc1
    buffer_load_dwordx4 v[180:183], v36, s[44:47], s77 offen sc1
    buffer_load_dwordx4 v[184:187], v36, s[44:47], s78 offen sc1
    buffer_load_dwordx4 v[188:191], v36, s[44:47], s79 offen sc1
L_np3:
    s_bitcmp1_b32 s62, 4
    s_cbranch_scc0 L_np4
    buffer_load_dwordx4 v[192:195], v36, s[44:47], s80 offen sc1
    buffer_load_dwordx4 v[196:199], v36, s[44:47], s81 offen sc1
    buffer_load_dwordx4 v[200:203], v36, s[44:47], s82 offen sc1
    buffer_load_dwordx4 v[204:207], v36, s[44:47], s83 offen sc1
L_np4:
    s_bitcmp1_b32 s62, 5
    s_cbranch_scc0 L_np5
    buffer_load_dwordx4 v[208:211], v36, s[44:47], s84 offen sc1
    buffer_load_dwordx4 v[212:215], v36, s[44:47], s85 offen sc1
    buffer_load_dwordx4 v[216:219], v36, s[44:47], s86 offen sc1
    buffer_load_dwordx4 v[220:223], v36, s[44:47], s87 offen sc1
L_np5:
    s_bitcmp1_b32 s62, 6
    s_cbranch_scc0 L_np6
    buffer_load_dwordx4 v[224:227], v36, s[44:47], s88 offen sc1
    buffer_load_dwordx4 v[228:231], v36, s[44:47], s89 offen sc1
    buffer_load_dwordx4 v[232:235], v36, s[44:47], s90 offen sc1
    buffer_load_dwordx4 v[236:239], v36, s[44:47], s91 offen sc1
L_np6:
    s_bitcmp1_b32 s62, 7
    s_cbranch_scc0 L_np7
    buffer_load_dwordx4 v[240:243], v36, s[44:47], s92 offen sc1
    buffer_load_dwordx4 v[244:247], v36, s[44:47], s93 offen sc1
    buffer_load_dwordx4 v[248:251], v36, s[44:47], s94 offen sc1
    buffer_load_dwordx4 v[252:255], v36, s[44:47], s95 offen sc1
L_np7:
    s_waitcnt vmcnt(0)
    s_bitcmp1_b32 s62, 0
    s_cbranch_scc0 L_nn0
    v_pk_add_f32 v[112:113], v[128:129], v[132:133]
    v_pk_add_f32 v[114:115], v[130:131], v[134:135]
    v_pk_add_f32 v[116:117], v[136:137], v[140:141]
    v_pk_add_f32 v[118:119], v[138:139], v[142:143]
    v_pk_add_f32 v[80:81], v[112:113], v[116:117]
    v_pk_add_f32 v[82:83], v[114:115], v[118:119]
L_nn0:
    s_bitcmp1_b32 s62, 1
    s_cbranch_scc0 L_nn1
    v_pk_add_f32 v[112:113], v[144:145], v[148:149]
    v_pk_add_f32 v[114:115], v[146:147], v[150:151]
    v_pk_add_f32 v[116:117], v[152:153], v[156:157]
    v_pk_add_f32 v[118:119], v[154:155], v[158:159]
    v_pk_add_f32 v[84:85], v[112:113], v[116:117]
    v_pk_add_f32 v[86:87], v[114:115], v[118:119]
L_nn1:
    s_bitcmp1_b32 s62, 2
    s_cbranch_scc0 L_nn2
    v_pk_add_f32 v[112:113], v[160:161], v[164:165]
    v_pk_add_f32 v[114:115], v[162:163], v[166:167]
    v_pk_add_f32 v[116:117], v[168:169], v[172:173]
    v_pk_add_f32 v[118:119], v[170:171], v[174:175]
    v_pk_add_f32 v[88:89], v[112:113], v[116:117]
    v_pk_add_f32 v[90:91], v[114:115], v[118:119]
L_nn2:
    s_bitcmp1_b32 s62, 3
    s_cbranch_scc0 L_nn3
    v_pk_add_f32 v[112:113], v[176:177], v[180:181]
    v_pk_add_f32 v[114:115], v[178:179], v[182:183]
    v_pk_add_f32 v[116:117], v[184:185], v[188:189]
    v_pk_add_f32 v[118:119], v[186:187], v[190:191]
    v_pk_add_f32 v[92:93], v[112:113], v[116:117]
    v_pk_add_f32 v[94:95], v[114:115], v[118:119]
L_nn3:
    s_bitcmp1_b32 s62, 4
    s_cbranch_scc0 L_nn4
    v_pk_add_f32 v[112:113], v[192:193], v[196:197]
    v_pk_add_f32 v[114:115], v[194:195], v[198:199]
    v_pk_add_f32 v[116:117], v[200:201], v[204:205]
    v_pk_add_f32 v[118:119], v[202:203], v[206:207]
    v_pk_add_f32 v[96:97], v[112:113], v[116:117]
    v_pk_add_f32 v[98:99], v[114:115], v[118:119]
L_nn4:
    s_bitcmp1_b32 s62, 5
    s_cbranch_scc0 L_nn5
    v_pk_add_f32 v[112:113], v[208:209], v[212:213]
    v_pk_add_f32 v[114:115], v[210:211], v[214:215]
    v_pk_add_f32 v[116:117], v[216:217], v[220:221]
    v_pk_add_f32 v[118:119], v[218:219], v[222:223]
    v_pk_add_f32 v[100:101], v[112:113], v[116:117]
    v_pk_add_f32 v[102:103], v[114:115], v[118:119]
L_nn5:
    s_bitcmp1_b32 s62, 6
    s_cbranch_scc0 L_nn6
    v_pk_add_f32 v[112:113], v[224:225], v[228:229]
    v_pk_add_f32 v[114:115], v[226:227], v[230:231]
    v_pk_add_f32 v[116:117], v[232:233], v[236:237]
    v_pk_add_f32 v[118:119], v[234:235], v[238:239]
    v_pk_add_f32 v[104:105], v[112:113], v[116:117]
    v_pk_add_f32 v[106:107], v[114:115], v[118:119]
L_nn6:
    s_bitcmp1_b32 s62, 7
    s_cbranch_scc0 L_nn7
    v_pk_add_f32 v[112:113], v[240:241], v[244:245]
    v_pk_add_f32 v[114:115], v[242:243], v[246:247]
    v_pk_add_f32 v[116:117], v[248:249], v[252:253]
    v_pk_add_f32 v[118:119], v[250:251], v[254:255]
    v_pk_add_f32 v[108:109], v[112:113], v[116:117]
    v_pk_add_f32 v[110:111], v[114:115], v[118:119]
L_nn7:
    s_branch L_sum
L_done:
    v_cvt_pk_bf16_f32 v22, v44, v45
    v_cvt_pk_bf16_f32 v23, v46, v47
    buffer_store_dwordx2 v[22:23], v37, s[48:51], 0 offen
L_fin:
    s_endpgm
L_xfb:
    s_waitcnt vmcnt(0) lgkmcnt(0)
    s_mul_i32 s7, s52, 1280
    s_mul_i32 s72, s6, 320
    s_add_u32 s72, s72, s7
    buffer_load_dwordx4 v[220:223], v229, s[40:43], s72 offen
    buffer_load_dword v224, v229, s[40:43], s72 offen offset:16
    s_add_u32 s7, s52, 1
    s_and_b32 s7, s7, 3
    s_mul_i32 s7, s7, 327680
    s_add_u32 s53, s57, s7
    buffer_load_dwordx4 a[40:43], v2, s[32:35], s53 offen nt
    s_add_u32 s53, s53, 8192
    buffer_load_dwordx4 a[44:47], v2, s[32:35], s53 offen nt
    s_add_u32 s53, s53, 8192
    buffer_load_dwordx4 a[48:51], v2, s[32:35], s53 offen nt
    s_add_u32 s53, s53, 8192
    buffer_load_dwordx4 a[52:55], v2, s[32:35], s53 offen nt
    s_add_u32 s53, s53, 8192
    buffer_load_dwordx4 a[56:59], v2, s[32:35], s53 offen nt
    s_add_u32 s53, s53, 8192
    buffer_load_dwordx4 a[60:63], v2, s[32:35], s53 offen nt
    s_add_u32 s53, s53, 8192
    buffer_load_dwordx4 a[64:67], v2, s[32:35], s53 offen nt
    s_add_u32 s53, s53, 8192
    buffer_load_dwordx4 a[68:71], v2, s[32:35], s53 offen nt
    s_add_u32 s53, s53, 8192
    s_waitcnt vmcnt(8)
    v_mul_u32_u24_sdwa v232, v220, v226 dst_sel:DWORD dst_unused:UNUSED_PAD src0_sel:WORD_0 src1_sel:DWORD
    v_mul_u32_u24_sdwa v233, v220, v227 dst_sel:DWORD dst_unused:UNUSED_PAD src0_sel:WORD_0 src1_sel:DWORD
    v_mul_u32_u24_sdwa v234, v220, v226 dst_sel:DWORD dst_unused:UNUSED_PAD src0_sel:WORD_1 src1_sel:DWORD
    v_mul_u32_u24_sdwa v235, v220, v227 dst_sel:DWORD dst_unused:UNUSED_PAD src0_sel:WORD_1 src1_sel:DWORD
    v_mul_u32_u24_sdwa v236, v221, v226 dst_sel:DWORD dst_unused:UNUSED_PAD src0_sel:WORD_0 src1_sel:DWORD
    v_mul_u32_u24_sdwa v237, v221, v227 dst_sel:DWORD dst_unused:UNUSED_PAD src0_sel:WORD_0 src1_sel:DWORD
    v_mul_u32_u24_sdwa v238, v221, v226 dst_sel:DWORD dst_unused:UNUSED_PAD src0_sel:WORD_1 src1_sel:DWORD
    v_mul_u32_u24_sdwa v239, v221, v227 dst_sel:DWORD dst_unused:UNUSED_PAD src0_sel:WORD_1 src1_sel:DWORD
    v_mul_u32_u24_sdwa v240, v222, v226 dst_sel:DWORD dst_unused:UNUSED_PAD src0_sel:WORD_0 src1_sel:DWORD
    v_mul_u32_u24_sdwa v241, v222, v227 dst_sel:DWORD dst_unused:UNUSED_PAD src0_sel:WORD_0 src1_sel:DWORD
    v_mul_u32_u24_sdwa v242, v222, v226 dst_sel:DWORD dst_unused:UNUSED_PAD src0_sel:WORD_1 src1_sel:DWORD
    v_mul_u32_u24_sdwa v243, v222, v227 dst_sel:DWORD dst_unused:UNUSED_PAD src0_sel:WORD_1 src1_sel:DWORD
    v_mul_u32_u24_sdwa v244, v223, v226 dst_sel:DWORD dst_unused:UNUSED_PAD src0_sel:WORD_0 src1_sel:DWORD
    v_mul_u32_u24_sdwa v245, v223, v227 dst_sel:DWORD dst_unused:UNUSED_PAD src0_sel:WORD_0 src1_sel:DWORD
    v_mul_u32_u24_sdwa v246, v223, v226 dst_sel:DWORD dst_unused:UNUSED_PAD src0_sel:WORD_1 src1_sel:DWORD
    v_mul_u32_u24_sdwa v247, v223, v227 dst_sel:DWORD dst_unused:UNUSED_PAD src0_sel:WORD_1 src1_sel:DWORD
    v_mul_u32_u24_sdwa v248, v224, v226 dst_sel:DWORD dst_unused:UNUSED_PAD src0_sel:WORD_0 src1_sel:DWORD
    v_mul_u32_u24_sdwa v249, v224, v227 dst_sel:DWORD dst_unused:UNUSED_PAD src0_sel:WORD_0 src1_sel:DWORD
    v_mul_u32_u24_sdwa v250, v224, v226 dst_sel:DWORD dst_unused:UNUSED_PAD src0_sel:WORD_1 src1_sel:DWORD
    v_mul_u32_u24_sdwa v251, v224, v227 dst_sel:DWORD dst_unused:UNUSED_PAD src0_sel:WORD_1 src1_sel:DWORD
    s_waitcnt vmcnt(7)
    buffer_load_dwordx4 a[72:75], v2, s[32:35], s53 offen nt
    s_add_u32 s53, s53, 8192
    v_mfma_f32_4x4x4_16b_bf16 v[52:55], v[232:233], a[40:41], 0 cbsz:2 abid:1
    v_mfma_f32_4x4x4_16b_bf16 v[56:59], v[232:233], a[42:43], 0 cbsz:2 abid:1
    s_waitcnt vmcnt(7)
    buffer_load_dwordx4 a[76:79], v2, s[32:35], s53 offen nt
    v_mfma_f32_4x4x4_16b_bf16 v[52:55], v[234:235], a[44:45], v[52:55] cbsz:2 abid:1
    v_mfma_f32_4x4x4_16b_bf16 v[56:59], v[234:235], a[46:47], v[56:59] cbsz:2 abid:1
    s_waitcnt vmcnt(7)
    s_add_u32 s7, s52, 2
    s_and_b32 s7, s7, 3
    s_mul_i32 s7, s7, 327680
    s_add_u32 s53, s57, s7
    buffer_load_dwordx4 a[80:83], v2, s[32:35], s53 offen nt
    s_add_u32 s53, s53, 8192
    v_mfma_f32_4x4x4_16b_bf16 v[52:55], v[236:237], a[48:49], v[52:55] cbsz:2 abid:1
    v_mfma_f32_4x4x4_16b_bf16 v[56:59], v[236:237], a[50:51], v[56:59] cbsz:2 abid:1
    s_waitcnt vmcnt(7)
    buffer_load_dwordx4 a[84:87], v2, s[32:35], s53 offen nt
    s_add_u32 s53, s53, 8192
    v_mfma_f32_4x4x4_16b_bf16 v[52:55], v[238:239], a[52:53], v[52:55] cbsz:2 abid:1
    v_mfma_f32_4x4x4_16b_bf16 v[56:59], v[238:239], a[54:55], v[56:59] cbsz:2 abid:1
    s_waitcnt vmcnt(7)
    buffer_load_dwordx4 a[88:91], v2, s[32:35], s53 offen nt
    s_add_u32 s53, s53, 8192
    v_mfma_f32_4x4x4_16b_bf16 v[52:55], v[240:241], a[56:57], v[52:55] cbsz:2 abid:1
    v_mfma_f32_4x4x4_16b_bf16 v[56:59], v[240:241], a[58:59], v[56:59] cbsz:2 abid:1
    s_waitcnt vmcnt(7)
    buffer_load_dwordx4 a[92:95], v2, s[32:35], s53 offen nt
    s_add_u32 s53, s53, 8192
    v_mfma_f32_4x4x4_16b_bf16 v[52:55], v[242:243], a[60:61], v[52:55] cbsz:2 abid:1
    v_mfma_f32_4x4x4_16b_bf16 v[56:59], v[242:243], a[62:63], v[56:59] cbsz:2 abid:1
    s_waitcnt vmcnt(7)
    buffer_load_dwordx4 a[96:99], v2, s[32:35], s53 offen nt
    s_add_u32 s53, s53, 8192
    v_mfma_f32_4x4x4_16b_bf16 v[52:55], v[244:245], a[64:65], v[52:55] cbsz:2 abid:1
    v_mfma_f32_4x4x4_16b_bf16 v[56:59], v[244:245], a[66:67], v[56:59] cbsz:2 abid:1
    s_waitcnt vmcnt(7)
    buffer_load_dwordx4 a[100:103], v2, s[32:35], s53 offen nt
    s_add_u32 s53, s53, 8192
    v_mfma_f32_4x4x4_16b_bf16 v[52:55], v[246:247], a[68:69], v[52:55] cbsz:2 abid:1
    v_mfma_f32_4x4x4_16b_bf16 v[56:59], v[246:247], a[70:71], v[56:59] cbsz:2 abid:1
    s_waitcnt vmcnt(7)
    buffer_load_dwordx4 a[104:107], v2, s[32:35], s53 offen nt
    s_add_u32 s53, s53, 8192
    v_mfma_f32_4x4x4_16b_bf16 v[52:55], v[248:249], a[72:73], v[52:55] cbsz:2 abid:1
    v_mfma_f32_4x4x4_16b_bf16 v[56:59], v[248:249], a[74:75], v[56:59] cbsz:2 abid:1
    s_waitcnt vmcnt(7)
    buffer_load_dwordx4 a[108:111], v2, s[32:35], s53 offen nt
    s_add_u32 s53, s53, 8192
    v_mfma_f32_4x4x4_16b_bf16 v[52:55], v[250:251], a[76:77], v[52:55] cbsz:2 abid:1
    v_mfma_f32_4x4x4_16b_bf16 v[56:59], v[250:251], a[78:79], v[56:59] cbsz:2 abid:1
    s_waitcnt vmcnt(7)
    buffer_load_dwordx4 a[112:115], v2, s[32:35], s53 offen nt
    s_add_u32 s53, s53, 8192
    v_mfma_f32_4x4x4_16b_bf16 v[60:63], v[232:233], a[80:81], 0 cbsz:2 abid:2
    v_mfma_f32_4x4x4_16b_bf16 v[64:67], v[232:233], a[82:83], 0 cbsz:2 abid:2
    s_waitcnt vmcnt(7)
    buffer_load_dwordx4 a[116:119], v2, s[32:35], s53 offen nt
    v_mfma_f32_4x4x4_16b_bf16 v[60:63], v[234:235], a[84:85], v[60:63] cbsz:2 abid:2
    v_mfma_f32_4x4x4_16b_bf16 v[64:67], v[234:235], a[86:87], v[64:67] cbsz:2 abid:2
    s_waitcnt vmcnt(7)
    s_add_u32 s7, s52, 3
    s_and_b32 s7, s7, 3
    s_mul_i32 s7, s7, 327680
    s_add_u32 s53, s57, s7
    buffer_load_dwordx4 a[120:123], v2, s[32:35], s53 offen nt
    s_add_u32 s53, s53, 8192
    v_mfma_f32_4x4x4_16b_bf16 v[60:63], v[236:237], a[88:89], v[60:63] cbsz:2 abid:2
    v_mfma_f32_4x4x4_16b_bf16 v[64:67], v[236:237], a[90:91], v[64:67] cbsz:2 abid:2
    s_waitcnt vmcnt(7)
    buffer_load_dwordx4 a[124:127], v2, s[32:35], s53 offen nt
    s_add_u32 s53, s53, 8192
    v_mfma_f32_4x4x4_16b_bf16 v[60:63], v[238:239], a[92:93], v[60:63] cbsz:2 abid:2
    v_mfma_f32_4x4x4_16b_bf16 v[64:67], v[238:239], a[94:95], v[64:67] cbsz:2 abid:2
    s_waitcnt vmcnt(7)
    buffer_load_dwordx4 a[128:131], v2, s[32:35], s53 offen nt
    s_add_u32 s53, s53, 8192
    v_mfma_f32_4x4x4_16b_bf16 v[60:63], v[240:241], a[96:97], v[60:63] cbsz:2 abid:2
    v_mfma_f32_4x4x4_16b_bf16 v[64:67], v[240:241], a[98:99], v[64:67] cbsz:2 abid:2
    s_waitcnt vmcnt(7)
    buffer_load_dwordx4 a[132:135], v2, s[32:35], s53 offen nt
    s_add_u32 s53, s53, 8192
    v_mfma_f32_4x4x4_16b_bf16 v[60:63], v[242:243], a[100:101], v[60:63] cbsz:2 abid:2
    v_mfma_f32_4x4x4_16b_bf16 v[64:67], v[242:243], a[102:103], v[64:67] cbsz:2 abid:2
    s_waitcnt vmcnt(7)
    buffer_load_dwordx4 a[136:139], v2, s[32:35], s53 offen nt
    s_add_u32 s53, s53, 8192
    v_mfma_f32_4x4x4_16b_bf16 v[60:63], v[244:245], a[104:105], v[60:63] cbsz:2 abid:2
    v_mfma_f32_4x4x4_16b_bf16 v[64:67], v[244:245], a[106:107], v[64:67] cbsz:2 abid:2
    s_waitcnt vmcnt(7)
    buffer_load_dwordx4 a[140:143], v2, s[32:35], s53 offen nt
    s_add_u32 s53, s53, 8192
    v_mfma_f32_4x4x4_16b_bf16 v[60:63], v[246:247], a[108:109], v[60:63] cbsz:2 abid:2
    v_mfma_f32_4x4x4_16b_bf16 v[64:67], v[246:247], a[110:111], v[64:67] cbsz:2 abid:2
    s_waitcnt vmcnt(7)
    buffer_load_dwordx4 a[144:147], v2, s[32:35], s53 offen nt
    s_add_u32 s53, s53, 8192
    v_mfma_f32_4x4x4_16b_bf16 v[60:63], v[248:249], a[112:113], v[60:63] cbsz:2 abid:2
    v_mfma_f32_4x4x4_16b_bf16 v[64:67], v[248:249], a[114:115], v[64:67] cbsz:2 abid:2
    s_waitcnt vmcnt(7)
    buffer_load_dwordx4 a[148:151], v2, s[32:35], s53 offen nt
    s_add_u32 s53, s53, 8192
    v_mfma_f32_4x4x4_16b_bf16 v[60:63], v[250:251], a[116:117], v[60:63] cbsz:2 abid:2
    v_mfma_f32_4x4x4_16b_bf16 v[64:67], v[250:251], a[118:119], v[64:67] cbsz:2 abid:2
    s_waitcnt vmcnt(7)
    buffer_load_dwordx4 a[152:155], v2, s[32:35], s53 offen nt
    s_add_u32 s53, s53, 8192
    v_mfma_f32_4x4x4_16b_bf16 v[68:71], v[232:233], a[120:121], 0 cbsz:2 abid:3
    v_mfma_f32_4x4x4_16b_bf16 v[72:75], v[232:233], a[122:123], 0 cbsz:2 abid:3
    s_waitcnt vmcnt(7)
    buffer_load_dwordx4 a[156:159], v2, s[32:35], s53 offen nt
    v_mfma_f32_4x4x4_16b_bf16 v[68:71], v[234:235], a[124:125], v[68:71] cbsz:2 abid:3
    v_mfma_f32_4x4x4_16b_bf16 v[72:75], v[234:235], a[126:127], v[72:75] cbsz:2 abid:3
    s_waitcnt vmcnt(7)
    v_mfma_f32_4x4x4_16b_bf16 v[68:71], v[236:237], a[128:129], v[68:71] cbsz:2 abid:3
    v_mfma_f32_4x4x4_16b_bf16 v[72:75], v[236:237], a[130:131], v[72:75] cbsz:2 abid:3
    s_waitcnt vmcnt(6)
    v_mfma_f32_4x4x4_16b_bf16 v[68:71], v[238:239], a[132:133], v[68:71] cbsz:2 abid:3
    v_mfma_f32_4x4x4_16b_bf16 v[72:75], v[238:239], a[134:135], v[72:75] cbsz:2 abid:3
    s_waitcnt vmcnt(5)
    v_mfma_f32_4x4x4_16b_bf16 v[68:71], v[240:241], a[136:137], v[68:71] cbsz:2 abid:3
    v_mfma_f32_4x4x4_16b_bf16 v[72:75], v[240:241], a[138:139], v[72:75] cbsz:2 abid:3
    s_waitcnt vmcnt(4)
    v_mfma_f32_4x4x4_16b_bf16 v[68:71], v[242:243], a[140:141], v[68:71] cbsz:2 abid:3
    v_mfma_f32_4x4x4_16b_bf16 v[72:75], v[242:243], a[142:143], v[72:75] cbsz:2 abid:3
    s_waitcnt vmcnt(3)
    v_mfma_f32_4x4x4_16b_bf16 v[68:71], v[244:245], a[144:145], v[68:71] cbsz:2 abid:3
    v_mfma_f32_4x4x4_16b_bf16 v[72:75], v[244:245], a[146:147], v[72:75] cbsz:2 abid:3
    s_waitcnt vmcnt(2)
    v_mfma_f32_4x4x4_16b_bf16 v[68:71], v[246:247], a[148:149], v[68:71] cbsz:2 abid:3
    v_mfma_f32_4x4x4_16b_bf16 v[72:75], v[246:247], a[150:151], v[72:75] cbsz:2 abid:3
    s_waitcnt vmcnt(1)
    v_mfma_f32_4x4x4_16b_bf16 v[68:71], v[248:249], a[152:153], v[68:71] cbsz:2 abid:3
    v_mfma_f32_4x4x4_16b_bf16 v[72:75], v[248:249], a[154:155], v[72:75] cbsz:2 abid:3
    s_waitcnt vmcnt(0)
    v_mfma_f32_4x4x4_16b_bf16 v[68:71], v[250:251], a[156:157], v[68:71] cbsz:2 abid:3
    v_mfma_f32_4x4x4_16b_bf16 v[72:75], v[250:251], a[158:159], v[72:75] cbsz:2 abid:3
    s_mul_i32 s7, s6, 1536
    v_add_u32 v174, s7, v38
    v_permlane32_swap_b32 v52, v56
    v_permlane32_swap_b32 v53, v57
    v_permlane32_swap_b32 v54, v58
    v_permlane32_swap_b32 v55, v59
    v_pk_add_f32 v[52:53], v[52:53], v[56:57]
    v_pk_add_f32 v[54:55], v[54:55], v[58:59]
    s_nop 1
    v_permlane16_swap_b32 v52, v54
    v_permlane16_swap_b32 v53, v55
    v_pk_add_f32 v[52:53], v[52:53], v[54:55]
    ds_write_b64 v174, v[52:53] offset:8704
    v_permlane32_swap_b32 v60, v64
    v_permlane32_swap_b32 v61, v65
    v_permlane32_swap_b32 v62, v66
    v_permlane32_swap_b32 v63, v67
    v_pk_add_f32 v[60:61], v[60:61], v[64:65]
    v_pk_add_f32 v[62:63], v[62:63], v[66:67]
    s_nop 1
    v_permlane16_swap_b32 v60, v62
    v_permlane16_swap_b32 v61, v63
    v_pk_add_f32 v[60:61], v[60:61], v[62:63]
    ds_write_b64 v174, v[60:61] offset:9216
    v_permlane32_swap_b32 v68, v72
    v_permlane32_swap_b32 v69, v73
    v_permlane32_swap_b32 v70, v74
    v_permlane32_swap_b32 v71, v75
    v_pk_add_f32 v[68:69], v[68:69], v[72:73]
    v_pk_add_f32 v[70:71], v[70:71], v[74:75]
    s_nop 1
    v_permlane16_swap_b32 v68, v70
    v_permlane16_swap_b32 v69, v71
    v_pk_add_f32 v[68:69], v[68:69], v[70:71]
    ds_write_b64 v174, v[68:69] offset:9728
    s_lshl_b32 s7, s6, 9
    v_add_u32 v175, s7, v225
    s_waitcnt lgkmcnt(0)
    s_barrier
    s_cmp_eq_u32 s6, 0
    s_cbranch_scc1 L_xfb2
    ds_read_b64 v[44:45], v175 offset:8192
    ds_read_b64 v[46:47], v175 offset:10240
    ds_read_b64 v[48:49], v175 offset:12288
    ds_read_b64 v[50:51], v175 offset:14336
    s_lshl_b32 s7, s70, 9
    v_add_u32 v175, s7, v225
    s_waitcnt lgkmcnt(0)
    v_pk_add_f32 v[44:45], v[44:45], v[46:47]
    v_pk_add_f32 v[48:49], v[48:49], v[50:51]
    v_pk_add_f32 v[76:77], v[44:45], v[48:49]
    ds_write_b64 v175, v[76:77] offset:0
L_xfb2:
    s_waitcnt lgkmcnt(0)
    s_barrier
    ds_read_b128 v[44:47], v230 offset:0
    ds_read_b128 v[48:51], v230 offset:16
    ds_read_b128 v[52:55], v230 offset:512
    ds_read_b128 v[56:59], v230 offset:528
    ds_read_b128 v[60:63], v230 offset:1024
    ds_read_b128 v[64:67], v230 offset:1040
    ds_read_b128 v[68:71], v230 offset:1536
    ds_read_b128 v[72:75], v230 offset:1552
    s_waitcnt lgkmcnt(0)
    s_nop 4
    s_branch L_xback
L_end:
    s_endpgm
.section .rodata,"a"
.p2align 6
.amdhsa_kernel concat_heads__gqa_block_cached__gqa_block_cached__decode_kernel
  .amdhsa_next_free_vgpr 416
  .amdhsa_next_free_sgpr 102
  .amdhsa_accum_offset 256
  .amdhsa_group_segment_fixed_size 0
  .amdhsa_kernarg_size 104
  .amdhsa_user_sgpr_count 2
  .amdhsa_user_sgpr_kernarg_segment_ptr 1
  .amdhsa_system_sgpr_workgroup_id_x 1
  .amdhsa_float_denorm_mode_32 3
.end_amdhsa_kernel
```
